```python
import torch

def _softmax(x, axis=-1):
    return torch.softmax(x, dim=axis)
def _gelu(x):
    return torch.nn.functional.gelu(x, approximate="tanh")
def _silu(x):
    return torch.nn.functional.silu(x)
def _sigmoid(x):
    return torch.sigmoid(x)
def _layernorm(x, axis=-1, eps=1e-5):
    m = x.mean(dim=axis, keepdim=True)
    v = x.var(dim=axis, keepdim=True, unbiased=False)
    return (x - m) / torch.sqrt(v + eps)
def _scatter_add(tgt, idx, src, axis=0):
    return tgt.clone().index_add_(axis, idx, src)
def _segment_sum(src, seg, n):
    out = torch.zeros((n,) + src.shape[1:], dtype=src.dtype)
    return out.index_add_(0, seg, src)
def _pad(x, pw):
    flat = tuple(v for pair in reversed(pw) for v in pair)
    return torch.nn.functional.pad(x, flat)

kernel_name = 'sequential_preLN__spectral_gfnet__geglu_ffn__prompt'

def setup_inputs():

    _w = (lambda a: (lambda t: t.to(torch.bfloat16) if t.is_floating_point() else t)(torch.as_tensor(a)))
    def _A_setup():
        B, S, D = 1, 2048, 512
        Df = D // 2 + 1
        return {
            "x": _w((lambda *s: torch.randn(*s, dtype=torch.bfloat16) * 0.05)(B, S, D)),
            "w_r": _w((lambda *s: torch.randn(*s, dtype=torch.bfloat16) * 0.4)(S, Df) * 0.02),
            "w_i": _w((lambda *s: torch.randn(*s, dtype=torch.bfloat16) * 0.4)(S, Df) * 0.02),
        }
    _A_in = _A_setup()

    def _B_setup():
        B, S, D, F = 1, 2048, 512, 1376
        return {
            "x": _w((lambda *s: torch.randn(*s, dtype=torch.bfloat16) * 0.05)(B, S, D)),
            "w_gate": _w((lambda *s: torch.randn(*s, dtype=torch.bfloat16) * 0.05)(D, F)),
            "w_up": _w((lambda *s: torch.randn(*s, dtype=torch.bfloat16) * 0.05)(D, F)),
            "w_down": _w((lambda *s: torch.randn(*s, dtype=torch.bfloat16) * 0.05)(F, D)),
        }
    _B_in = _B_setup()

    return {
        "A_x": _A_in["x"],
        "A_w_r": _A_in["w_r"],
        "A_w_i": _A_in["w_i"],
        "B_x": _B_in["x"],
        "B_w_gate": _B_in["w_gate"],
        "B_w_up": _B_in["w_up"],
        "B_w_down": _B_in["w_down"],
    }

def reference(A_x, A_w_r, A_w_i, B_x, B_w_gate, B_w_up, B_w_down):
    def _A_ref(x, w_r, w_i):
        B, S, D = x.shape
        X = (lambda x, axes=(-2,-1): torch.fft.rfft2(x.float(), dim=axes))(x, axes=(-2, -1))
        W = w_r + 1j * w_i
        X = X * W
        y = (lambda x, s, axes=(-2,-1): torch.fft.irfft2(x, s=s, dim=axes).to(torch.bfloat16))(X, (S, D), axes=(-2, -1))
        return y

    def _B_ref(x, w_gate, w_up, w_down):
        return (_gelu(x @ w_gate) * (x @ w_up)) @ w_down

    x = A_x
    h = x + _A_ref(_layernorm(x, axis=-1), A_w_r, A_w_i)
    h2 = h + _B_ref(_layernorm(h, axis=-1), B_w_gate, B_w_up, B_w_down)
    return h2
```

```asm
; @launch kernel=k1_kernel grid=(388,1,1) block=(256,1,1) lds=18432
; @launch kernel=k2_kernel grid=(257,1,1) block=(256,1,1) lds=32768
; @launch kernel=k3_kernel grid=(256,1,1) block=(256,1,1) lds=18432
; @launch kernel=k4_kernel grid=(352,1,1) block=(256,1,1) lds=73728
; @launch kernel=k5_kernel grid=(128,1,1) block=(256,1,1) lds=73728
.amdgcn_target "amdgcn-amd-amdhsa--gfx950"
.text
.globl k1_kernel
.p2align 8
.type k1_kernel,@function
k1_kernel:
    s_load_dwordx16 s[16:31], s[0:1], 0
    s_load_dwordx4 s[32:35], s[0:1], 64
    s_waitcnt lgkmcnt(0)
    s_cmp_ge_u32 s2, 256
    s_cbranch_scc1 K1_TR
    s_mov_b32 s4, s16
    s_mov_b32 s5, s17
    s_and_b32 s5, s5, 0xffff
    s_mov_b32 s6, 0x200000
    s_mov_b32 s7, 0x20000
    s_mov_b32 s8, s34
    s_mov_b32 s9, s35
    s_and_b32 s9, s9, 0xffff
    s_mov_b32 s10, 0x404000
    s_mov_b32 s11, 0x20000
    v_and_b32 v1, 63, v0
    v_lshrrev_b32 v8, 6, v0
    v_mul_u32_u24 v2, 4608, v8
    s_lshl_b32 s3, s2, 2
    v_add_u32 v8, s3, v8
    v_lshlrev_b32 v9, 11, v8
    v_lshlrev_b32 v10, 1, v1
    v_add_u32 v9, v9, v10
    buffer_load_ushort v16, v9, s[4:7], 0 offen offset:0
    buffer_load_ushort v17, v9, s[4:7], 0 offen offset:1024
    buffer_load_ushort v18, v9, s[4:7], 0 offen offset:128
    buffer_load_ushort v19, v9, s[4:7], 0 offen offset:1152
    buffer_load_ushort v20, v9, s[4:7], 0 offen offset:256
    buffer_load_ushort v21, v9, s[4:7], 0 offen offset:1280
    buffer_load_ushort v22, v9, s[4:7], 0 offen offset:384
    buffer_load_ushort v23, v9, s[4:7], 0 offen offset:1408
    buffer_load_ushort v24, v9, s[4:7], 0 offen offset:512
    buffer_load_ushort v25, v9, s[4:7], 0 offen offset:1536
    buffer_load_ushort v26, v9, s[4:7], 0 offen offset:640
    buffer_load_ushort v27, v9, s[4:7], 0 offen offset:1664
    buffer_load_ushort v28, v9, s[4:7], 0 offen offset:768
    buffer_load_ushort v29, v9, s[4:7], 0 offen offset:1792
    buffer_load_ushort v30, v9, s[4:7], 0 offen offset:896
    buffer_load_ushort v31, v9, s[4:7], 0 offen offset:1920
    s_waitcnt vmcnt(0)
    v_lshlrev_b32 v16, 16, v16
    v_lshlrev_b32 v17, 16, v17
    v_lshlrev_b32 v18, 16, v18
    v_lshlrev_b32 v19, 16, v19
    v_lshlrev_b32 v20, 16, v20
    v_lshlrev_b32 v21, 16, v21
    v_lshlrev_b32 v22, 16, v22
    v_lshlrev_b32 v23, 16, v23
    v_lshlrev_b32 v24, 16, v24
    v_lshlrev_b32 v25, 16, v25
    v_lshlrev_b32 v26, 16, v26
    v_lshlrev_b32 v27, 16, v27
    v_lshlrev_b32 v28, 16, v28
    v_lshlrev_b32 v29, 16, v29
    v_lshlrev_b32 v30, 16, v30
    v_lshlrev_b32 v31, 16, v31
    v_add_f32 v76, v16, v18
    v_add_f32 v76, v76, v20
    v_add_f32 v76, v76, v22
    v_add_f32 v76, v76, v24
    v_add_f32 v76, v76, v26
    v_add_f32 v76, v76, v28
    v_add_f32 v76, v76, v30
    v_add_f32 v77, v17, v19
    v_add_f32 v77, v77, v21
    v_add_f32 v77, v77, v23
    v_add_f32 v77, v77, v25
    v_add_f32 v77, v77, v27
    v_add_f32 v77, v77, v29
    v_add_f32 v77, v77, v31
    v_xor_b32 v70, 32, v1
    v_lshlrev_b32 v70, 2, v70
    ds_bpermute_b32 v71, v70, v76
    ds_bpermute_b32 v72, v70, v77
    s_waitcnt lgkmcnt(0)
    v_add_f32 v76, v76, v71
    v_add_f32 v77, v77, v72
    v_xor_b32 v70, 16, v1
    v_lshlrev_b32 v70, 2, v70
    ds_bpermute_b32 v71, v70, v76
    ds_bpermute_b32 v72, v70, v77
    s_waitcnt lgkmcnt(0)
    v_add_f32 v76, v76, v71
    v_add_f32 v77, v77, v72
    v_xor_b32 v70, 8, v1
    v_lshlrev_b32 v70, 2, v70
    ds_bpermute_b32 v71, v70, v76
    ds_bpermute_b32 v72, v70, v77
    s_waitcnt lgkmcnt(0)
    v_add_f32 v76, v76, v71
    v_add_f32 v77, v77, v72
    v_xor_b32 v70, 4, v1
    v_lshlrev_b32 v70, 2, v70
    ds_bpermute_b32 v71, v70, v76
    ds_bpermute_b32 v72, v70, v77
    s_waitcnt lgkmcnt(0)
    v_add_f32 v76, v76, v71
    v_add_f32 v77, v77, v72
    v_xor_b32 v70, 2, v1
    v_lshlrev_b32 v70, 2, v70
    ds_bpermute_b32 v71, v70, v76
    ds_bpermute_b32 v72, v70, v77
    s_waitcnt lgkmcnt(0)
    v_add_f32 v76, v76, v71
    v_add_f32 v77, v77, v72
    v_xor_b32 v70, 1, v1
    v_lshlrev_b32 v70, 2, v70
    ds_bpermute_b32 v71, v70, v76
    ds_bpermute_b32 v72, v70, v77
    s_waitcnt lgkmcnt(0)
    v_add_f32 v76, v76, v71
    v_add_f32 v77, v77, v72
    v_mul_f32 v76, 0x3b000000, v76
    v_mul_f32 v77, 0x3b000000, v77
    v_mov_b32 v78, 0
    v_sub_f32 v70, v16, v76
    v_fmac_f32 v78, v70, v70
    v_sub_f32 v70, v18, v76
    v_fmac_f32 v78, v70, v70
    v_sub_f32 v70, v20, v76
    v_fmac_f32 v78, v70, v70
    v_sub_f32 v70, v22, v76
    v_fmac_f32 v78, v70, v70
    v_sub_f32 v70, v24, v76
    v_fmac_f32 v78, v70, v70
    v_sub_f32 v70, v26, v76
    v_fmac_f32 v78, v70, v70
    v_sub_f32 v70, v28, v76
    v_fmac_f32 v78, v70, v70
    v_sub_f32 v70, v30, v76
    v_fmac_f32 v78, v70, v70
    v_mov_b32 v79, 0
    v_sub_f32 v70, v17, v77
    v_fmac_f32 v79, v70, v70
    v_sub_f32 v70, v19, v77
    v_fmac_f32 v79, v70, v70
    v_sub_f32 v70, v21, v77
    v_fmac_f32 v79, v70, v70
    v_sub_f32 v70, v23, v77
    v_fmac_f32 v79, v70, v70
    v_sub_f32 v70, v25, v77
    v_fmac_f32 v79, v70, v70
    v_sub_f32 v70, v27, v77
    v_fmac_f32 v79, v70, v70
    v_sub_f32 v70, v29, v77
    v_fmac_f32 v79, v70, v70
    v_sub_f32 v70, v31, v77
    v_fmac_f32 v79, v70, v70
    v_xor_b32 v70, 32, v1
    v_lshlrev_b32 v70, 2, v70
    ds_bpermute_b32 v71, v70, v78
    ds_bpermute_b32 v72, v70, v79
    s_waitcnt lgkmcnt(0)
    v_add_f32 v78, v78, v71
    v_add_f32 v79, v79, v72
    v_xor_b32 v70, 16, v1
    v_lshlrev_b32 v70, 2, v70
    ds_bpermute_b32 v71, v70, v78
    ds_bpermute_b32 v72, v70, v79
    s_waitcnt lgkmcnt(0)
    v_add_f32 v78, v78, v71
    v_add_f32 v79, v79, v72
    v_xor_b32 v70, 8, v1
    v_lshlrev_b32 v70, 2, v70
    ds_bpermute_b32 v71, v70, v78
    ds_bpermute_b32 v72, v70, v79
    s_waitcnt lgkmcnt(0)
    v_add_f32 v78, v78, v71
    v_add_f32 v79, v79, v72
    v_xor_b32 v70, 4, v1
    v_lshlrev_b32 v70, 2, v70
    ds_bpermute_b32 v71, v70, v78
    ds_bpermute_b32 v72, v70, v79
    s_waitcnt lgkmcnt(0)
    v_add_f32 v78, v78, v71
    v_add_f32 v79, v79, v72
    v_xor_b32 v70, 2, v1
    v_lshlrev_b32 v70, 2, v70
    ds_bpermute_b32 v71, v70, v78
    ds_bpermute_b32 v72, v70, v79
    s_waitcnt lgkmcnt(0)
    v_add_f32 v78, v78, v71
    v_add_f32 v79, v79, v72
    v_xor_b32 v70, 1, v1
    v_lshlrev_b32 v70, 2, v70
    ds_bpermute_b32 v71, v70, v78
    ds_bpermute_b32 v72, v70, v79
    s_waitcnt lgkmcnt(0)
    v_add_f32 v78, v78, v71
    v_add_f32 v79, v79, v72
    v_mul_f32 v78, 0x3b000000, v78
    v_cvt_pk_bf16_f32 v78, v78, v78
    v_lshlrev_b32 v78, 16, v78
    v_add_f32 v78, 0x3727c5ac, v78
    v_cvt_pk_bf16_f32 v78, v78, v78
    v_lshlrev_b32 v78, 16, v78
    v_sqrt_f32 v78, v78
    s_nop 0
    v_cvt_pk_bf16_f32 v78, v78, v78
    v_lshlrev_b32 v78, 16, v78
    v_rcp_f32 v78, v78
    v_cvt_pk_bf16_f32 v76, v76, v76
    v_lshlrev_b32 v76, 16, v76
    v_sub_f32 v16, v16, v76
    v_cvt_pk_bf16_f32 v16, v16, v16
    v_lshlrev_b32 v16, 16, v16
    v_mul_f32 v16, v16, v78
    v_cvt_pk_bf16_f32 v16, v16, v16
    v_lshlrev_b32 v16, 16, v16
    v_sub_f32 v18, v18, v76
    v_cvt_pk_bf16_f32 v18, v18, v18
    v_lshlrev_b32 v18, 16, v18
    v_mul_f32 v18, v18, v78
    v_cvt_pk_bf16_f32 v18, v18, v18
    v_lshlrev_b32 v18, 16, v18
    v_sub_f32 v20, v20, v76
    v_cvt_pk_bf16_f32 v20, v20, v20
    v_lshlrev_b32 v20, 16, v20
    v_mul_f32 v20, v20, v78
    v_cvt_pk_bf16_f32 v20, v20, v20
    v_lshlrev_b32 v20, 16, v20
    v_sub_f32 v22, v22, v76
    v_cvt_pk_bf16_f32 v22, v22, v22
    v_lshlrev_b32 v22, 16, v22
    v_mul_f32 v22, v22, v78
    v_cvt_pk_bf16_f32 v22, v22, v22
    v_lshlrev_b32 v22, 16, v22
    v_sub_f32 v24, v24, v76
    v_cvt_pk_bf16_f32 v24, v24, v24
    v_lshlrev_b32 v24, 16, v24
    v_mul_f32 v24, v24, v78
    v_cvt_pk_bf16_f32 v24, v24, v24
    v_lshlrev_b32 v24, 16, v24
    v_sub_f32 v26, v26, v76
    v_cvt_pk_bf16_f32 v26, v26, v26
    v_lshlrev_b32 v26, 16, v26
    v_mul_f32 v26, v26, v78
    v_cvt_pk_bf16_f32 v26, v26, v26
    v_lshlrev_b32 v26, 16, v26
    v_sub_f32 v28, v28, v76
    v_cvt_pk_bf16_f32 v28, v28, v28
    v_lshlrev_b32 v28, 16, v28
    v_mul_f32 v28, v28, v78
    v_cvt_pk_bf16_f32 v28, v28, v28
    v_lshlrev_b32 v28, 16, v28
    v_sub_f32 v30, v30, v76
    v_cvt_pk_bf16_f32 v30, v30, v30
    v_lshlrev_b32 v30, 16, v30
    v_mul_f32 v30, v30, v78
    v_cvt_pk_bf16_f32 v30, v30, v30
    v_lshlrev_b32 v30, 16, v30
    v_mul_f32 v79, 0x3b000000, v79
    v_cvt_pk_bf16_f32 v79, v79, v79
    v_lshlrev_b32 v79, 16, v79
    v_add_f32 v79, 0x3727c5ac, v79
    v_cvt_pk_bf16_f32 v79, v79, v79
    v_lshlrev_b32 v79, 16, v79
    v_sqrt_f32 v79, v79
    s_nop 0
    v_cvt_pk_bf16_f32 v79, v79, v79
    v_lshlrev_b32 v79, 16, v79
    v_rcp_f32 v79, v79
    v_cvt_pk_bf16_f32 v77, v77, v77
    v_lshlrev_b32 v77, 16, v77
    v_sub_f32 v17, v17, v77
    v_cvt_pk_bf16_f32 v17, v17, v17
    v_lshlrev_b32 v17, 16, v17
    v_mul_f32 v17, v17, v79
    v_cvt_pk_bf16_f32 v17, v17, v17
    v_lshlrev_b32 v17, 16, v17
    v_sub_f32 v19, v19, v77
    v_cvt_pk_bf16_f32 v19, v19, v19
    v_lshlrev_b32 v19, 16, v19
    v_mul_f32 v19, v19, v79
    v_cvt_pk_bf16_f32 v19, v19, v19
    v_lshlrev_b32 v19, 16, v19
    v_sub_f32 v21, v21, v77
    v_cvt_pk_bf16_f32 v21, v21, v21
    v_lshlrev_b32 v21, 16, v21
    v_mul_f32 v21, v21, v79
    v_cvt_pk_bf16_f32 v21, v21, v21
    v_lshlrev_b32 v21, 16, v21
    v_sub_f32 v23, v23, v77
    v_cvt_pk_bf16_f32 v23, v23, v23
    v_lshlrev_b32 v23, 16, v23
    v_mul_f32 v23, v23, v79
    v_cvt_pk_bf16_f32 v23, v23, v23
    v_lshlrev_b32 v23, 16, v23
    v_sub_f32 v25, v25, v77
    v_cvt_pk_bf16_f32 v25, v25, v25
    v_lshlrev_b32 v25, 16, v25
    v_mul_f32 v25, v25, v79
    v_cvt_pk_bf16_f32 v25, v25, v25
    v_lshlrev_b32 v25, 16, v25
    v_sub_f32 v27, v27, v77
    v_cvt_pk_bf16_f32 v27, v27, v27
    v_lshlrev_b32 v27, 16, v27
    v_mul_f32 v27, v27, v79
    v_cvt_pk_bf16_f32 v27, v27, v27
    v_lshlrev_b32 v27, 16, v27
    v_sub_f32 v29, v29, v77
    v_cvt_pk_bf16_f32 v29, v29, v29
    v_lshlrev_b32 v29, 16, v29
    v_mul_f32 v29, v29, v79
    v_cvt_pk_bf16_f32 v29, v29, v29
    v_lshlrev_b32 v29, 16, v29
    v_sub_f32 v31, v31, v77
    v_cvt_pk_bf16_f32 v31, v31, v31
    v_lshlrev_b32 v31, 16, v31
    v_mul_f32 v31, v31, v79
    v_cvt_pk_bf16_f32 v31, v31, v31
    v_lshlrev_b32 v31, 16, v31
    v_add_f32 v32, v16, v24
    v_add_f32 v33, v17, v25
    v_sub_f32 v34, v16, v24
    v_sub_f32 v35, v17, v25
    v_add_f32 v36, v20, v28
    v_add_f32 v37, v21, v29
    v_sub_f32 v38, v20, v28
    v_sub_f32 v39, v21, v29
    v_add_f32 v40, v18, v26
    v_add_f32 v41, v19, v27
    v_sub_f32 v42, v18, v26
    v_sub_f32 v43, v19, v27
    v_add_f32 v44, v22, v30
    v_add_f32 v45, v23, v31
    v_sub_f32 v46, v22, v30
    v_sub_f32 v47, v23, v31
    v_add_f32 v48, v32, v36
    v_add_f32 v49, v33, v37
    v_sub_f32 v52, v32, v36
    v_sub_f32 v53, v33, v37
    v_mov_b32 v16, v39
    v_sub_f32 v17, 0, v38
    v_add_f32 v50, v34, v16
    v_add_f32 v51, v35, v17
    v_sub_f32 v54, v34, v16
    v_sub_f32 v55, v35, v17
    v_add_f32 v56, v40, v44
    v_add_f32 v57, v41, v45
    v_sub_f32 v60, v40, v44
    v_sub_f32 v61, v41, v45
    v_mov_b32 v16, v47
    v_sub_f32 v17, 0, v46
    v_add_f32 v58, v42, v16
    v_add_f32 v59, v43, v17
    v_sub_f32 v62, v42, v16
    v_sub_f32 v63, v43, v17
    v_add_f32 v18, v58, v59
    v_sub_f32 v19, v59, v58
    v_mul_f32 v58, 0x3f3504f3, v18
    v_mul_f32 v59, 0x3f3504f3, v19
    v_sub_f32 v18, v62, v63
    v_add_f32 v19, v63, v62
    v_mul_f32 v62, 0xbf3504f3, v18
    v_mul_f32 v63, 0xbf3504f3, v19
    v_mov_b32 v20, v61
    v_sub_f32 v21, 0, v60
    v_mov_b32 v60, v20
    v_mov_b32 v61, v21
    v_add_f32 v16, v48, v56
    v_add_f32 v17, v49, v57
    v_sub_f32 v24, v48, v56
    v_sub_f32 v25, v49, v57
    v_add_f32 v18, v50, v58
    v_add_f32 v19, v51, v59
    v_sub_f32 v26, v50, v58
    v_sub_f32 v27, v51, v59
    v_add_f32 v20, v52, v60
    v_add_f32 v21, v53, v61
    v_sub_f32 v28, v52, v60
    v_sub_f32 v29, v53, v61
    v_add_f32 v22, v54, v62
    v_add_f32 v23, v55, v63
    v_sub_f32 v30, v54, v62
    v_sub_f32 v31, v55, v63
    v_lshlrev_b32 v3, 3, v1
    v_add_u32 v3, v3, v2
    ds_write_b64 v3, v[16:17] offset:0
    ds_write_b64 v3, v[18:19] offset:512
    ds_write_b64 v3, v[20:21] offset:1024
    ds_write_b64 v3, v[22:23] offset:1536
    ds_write_b64 v3, v[24:25] offset:2048
    ds_write_b64 v3, v[26:27] offset:2560
    ds_write_b64 v3, v[28:29] offset:3072
    ds_write_b64 v3, v[30:31] offset:3584
    v_lshrrev_b32 v4, 3, v1
    v_and_b32 v5, 7, v1
    v_lshlrev_b32 v6, 9, v4
    v_lshlrev_b32 v7, 3, v5
    v_add_u32 v6, v6, v7
    v_add_u32 v6, v6, v2
    s_waitcnt lgkmcnt(0)
    ds_read_b64 v[16:17], v6 offset:0
    ds_read_b64 v[18:19], v6 offset:64
    ds_read_b64 v[20:21], v6 offset:128
    ds_read_b64 v[22:23], v6 offset:192
    ds_read_b64 v[24:25], v6 offset:256
    ds_read_b64 v[26:27], v6 offset:320
    ds_read_b64 v[28:29], v6 offset:384
    ds_read_b64 v[30:31], v6 offset:448
    s_waitcnt lgkmcnt(0)
    v_mul_u32_u24 v64, 1, v4
    v_cvt_f32_u32 v64, v64
    v_mul_f32 v64, 0x3c800000, v64
    v_cos_f32 v65, v64
    v_sin_f32 v66, v64
    s_nop 0
    v_sub_f32 v66, 0, v66
    v_mul_f32 v67, v19, v66
    v_mul_f32 v68, v19, v65
    v_fma_f32 v19, v18, v66, v68
    v_fma_f32 v18, v18, v65, -v67
    v_mul_u32_u24 v64, 2, v4
    v_cvt_f32_u32 v64, v64
    v_mul_f32 v64, 0x3c800000, v64
    v_cos_f32 v65, v64
    v_sin_f32 v66, v64
    s_nop 0
    v_sub_f32 v66, 0, v66
    v_mul_f32 v67, v21, v66
    v_mul_f32 v68, v21, v65
    v_fma_f32 v21, v20, v66, v68
    v_fma_f32 v20, v20, v65, -v67
    v_mul_u32_u24 v64, 3, v4
    v_cvt_f32_u32 v64, v64
    v_mul_f32 v64, 0x3c800000, v64
    v_cos_f32 v65, v64
    v_sin_f32 v66, v64
    s_nop 0
    v_sub_f32 v66, 0, v66
    v_mul_f32 v67, v23, v66
    v_mul_f32 v68, v23, v65
    v_fma_f32 v23, v22, v66, v68
    v_fma_f32 v22, v22, v65, -v67
    v_mul_u32_u24 v64, 4, v4
    v_cvt_f32_u32 v64, v64
    v_mul_f32 v64, 0x3c800000, v64
    v_cos_f32 v65, v64
    v_sin_f32 v66, v64
    s_nop 0
    v_sub_f32 v66, 0, v66
    v_mul_f32 v67, v25, v66
    v_mul_f32 v68, v25, v65
    v_fma_f32 v25, v24, v66, v68
    v_fma_f32 v24, v24, v65, -v67
    v_mul_u32_u24 v64, 5, v4
    v_cvt_f32_u32 v64, v64
    v_mul_f32 v64, 0x3c800000, v64
    v_cos_f32 v65, v64
    v_sin_f32 v66, v64
    s_nop 0
    v_sub_f32 v66, 0, v66
    v_mul_f32 v67, v27, v66
    v_mul_f32 v68, v27, v65
    v_fma_f32 v27, v26, v66, v68
    v_fma_f32 v26, v26, v65, -v67
    v_mul_u32_u24 v64, 6, v4
    v_cvt_f32_u32 v64, v64
    v_mul_f32 v64, 0x3c800000, v64
    v_cos_f32 v65, v64
    v_sin_f32 v66, v64
    s_nop 0
    v_sub_f32 v66, 0, v66
    v_mul_f32 v67, v29, v66
    v_mul_f32 v68, v29, v65
    v_fma_f32 v29, v28, v66, v68
    v_fma_f32 v28, v28, v65, -v67
    v_mul_u32_u24 v64, 7, v4
    v_cvt_f32_u32 v64, v64
    v_mul_f32 v64, 0x3c800000, v64
    v_cos_f32 v65, v64
    v_sin_f32 v66, v64
    s_nop 0
    v_sub_f32 v66, 0, v66
    v_mul_f32 v67, v31, v66
    v_mul_f32 v68, v31, v65
    v_fma_f32 v31, v30, v66, v68
    v_fma_f32 v30, v30, v65, -v67
    v_add_f32 v32, v16, v24
    v_add_f32 v33, v17, v25
    v_sub_f32 v34, v16, v24
    v_sub_f32 v35, v17, v25
    v_add_f32 v36, v20, v28
    v_add_f32 v37, v21, v29
    v_sub_f32 v38, v20, v28
    v_sub_f32 v39, v21, v29
    v_add_f32 v40, v18, v26
    v_add_f32 v41, v19, v27
    v_sub_f32 v42, v18, v26
    v_sub_f32 v43, v19, v27
    v_add_f32 v44, v22, v30
    v_add_f32 v45, v23, v31
    v_sub_f32 v46, v22, v30
    v_sub_f32 v47, v23, v31
    v_add_f32 v48, v32, v36
    v_add_f32 v49, v33, v37
    v_sub_f32 v52, v32, v36
    v_sub_f32 v53, v33, v37
    v_mov_b32 v16, v39
    v_sub_f32 v17, 0, v38
    v_add_f32 v50, v34, v16
    v_add_f32 v51, v35, v17
    v_sub_f32 v54, v34, v16
    v_sub_f32 v55, v35, v17
    v_add_f32 v56, v40, v44
    v_add_f32 v57, v41, v45
    v_sub_f32 v60, v40, v44
    v_sub_f32 v61, v41, v45
    v_mov_b32 v16, v47
    v_sub_f32 v17, 0, v46
    v_add_f32 v58, v42, v16
    v_add_f32 v59, v43, v17
    v_sub_f32 v62, v42, v16
    v_sub_f32 v63, v43, v17
    v_add_f32 v18, v58, v59
    v_sub_f32 v19, v59, v58
    v_mul_f32 v58, 0x3f3504f3, v18
    v_mul_f32 v59, 0x3f3504f3, v19
    v_sub_f32 v18, v62, v63
    v_add_f32 v19, v63, v62
    v_mul_f32 v62, 0xbf3504f3, v18
    v_mul_f32 v63, 0xbf3504f3, v19
    v_mov_b32 v20, v61
    v_sub_f32 v21, 0, v60
    v_mov_b32 v60, v20
    v_mov_b32 v61, v21
    v_add_f32 v16, v48, v56
    v_add_f32 v17, v49, v57
    v_sub_f32 v24, v48, v56
    v_sub_f32 v25, v49, v57
    v_add_f32 v18, v50, v58
    v_add_f32 v19, v51, v59
    v_sub_f32 v26, v50, v58
    v_sub_f32 v27, v51, v59
    v_add_f32 v20, v52, v60
    v_add_f32 v21, v53, v61
    v_sub_f32 v28, v52, v60
    v_sub_f32 v29, v53, v61
    v_add_f32 v22, v54, v62
    v_add_f32 v23, v55, v63
    v_sub_f32 v30, v54, v62
    v_sub_f32 v31, v55, v63
    ds_write_b64 v6, v[16:17] offset:0
    ds_write_b64 v6, v[18:19] offset:64
    ds_write_b64 v6, v[20:21] offset:128
    ds_write_b64 v6, v[22:23] offset:192
    ds_write_b64 v6, v[24:25] offset:256
    ds_write_b64 v6, v[26:27] offset:320
    ds_write_b64 v6, v[28:29] offset:384
    ds_write_b64 v6, v[30:31] offset:448
    v_lshlrev_b32 v6, 6, v1
    v_add_u32 v6, v6, v2
    s_waitcnt lgkmcnt(0)
    ds_read_b64 v[16:17], v6 offset:0
    ds_read_b64 v[18:19], v6 offset:8
    ds_read_b64 v[20:21], v6 offset:16
    ds_read_b64 v[22:23], v6 offset:24
    ds_read_b64 v[24:25], v6 offset:32
    ds_read_b64 v[26:27], v6 offset:40
    ds_read_b64 v[28:29], v6 offset:48
    ds_read_b64 v[30:31], v6 offset:56
    v_lshlrev_b32 v7, 3, v5
    v_add_u32 v7, v7, v4
    s_waitcnt lgkmcnt(0)
    v_mul_u32_u24 v64, 1, v7
    v_cvt_f32_u32 v64, v64
    v_mul_f32 v64, 0x3b000000, v64
    v_cos_f32 v65, v64
    v_sin_f32 v66, v64
    s_nop 0
    v_sub_f32 v66, 0, v66
    v_mul_f32 v67, v19, v66
    v_mul_f32 v68, v19, v65
    v_fma_f32 v19, v18, v66, v68
    v_fma_f32 v18, v18, v65, -v67
    v_mul_u32_u24 v64, 2, v7
    v_cvt_f32_u32 v64, v64
    v_mul_f32 v64, 0x3b000000, v64
    v_cos_f32 v65, v64
    v_sin_f32 v66, v64
    s_nop 0
    v_sub_f32 v66, 0, v66
    v_mul_f32 v67, v21, v66
    v_mul_f32 v68, v21, v65
    v_fma_f32 v21, v20, v66, v68
    v_fma_f32 v20, v20, v65, -v67
    v_mul_u32_u24 v64, 3, v7
    v_cvt_f32_u32 v64, v64
    v_mul_f32 v64, 0x3b000000, v64
    v_cos_f32 v65, v64
    v_sin_f32 v66, v64
    s_nop 0
    v_sub_f32 v66, 0, v66
    v_mul_f32 v67, v23, v66
    v_mul_f32 v68, v23, v65
    v_fma_f32 v23, v22, v66, v68
    v_fma_f32 v22, v22, v65, -v67
    v_mul_u32_u24 v64, 4, v7
    v_cvt_f32_u32 v64, v64
    v_mul_f32 v64, 0x3b000000, v64
    v_cos_f32 v65, v64
    v_sin_f32 v66, v64
    s_nop 0
    v_sub_f32 v66, 0, v66
    v_mul_f32 v67, v25, v66
    v_mul_f32 v68, v25, v65
    v_fma_f32 v25, v24, v66, v68
    v_fma_f32 v24, v24, v65, -v67
    v_mul_u32_u24 v64, 5, v7
    v_cvt_f32_u32 v64, v64
    v_mul_f32 v64, 0x3b000000, v64
    v_cos_f32 v65, v64
    v_sin_f32 v66, v64
    s_nop 0
    v_sub_f32 v66, 0, v66
    v_mul_f32 v67, v27, v66
    v_mul_f32 v68, v27, v65
    v_fma_f32 v27, v26, v66, v68
    v_fma_f32 v26, v26, v65, -v67
    v_mul_u32_u24 v64, 6, v7
    v_cvt_f32_u32 v64, v64
    v_mul_f32 v64, 0x3b000000, v64
    v_cos_f32 v65, v64
    v_sin_f32 v66, v64
    s_nop 0
    v_sub_f32 v66, 0, v66
    v_mul_f32 v67, v29, v66
    v_mul_f32 v68, v29, v65
    v_fma_f32 v29, v28, v66, v68
    v_fma_f32 v28, v28, v65, -v67
    v_mul_u32_u24 v64, 7, v7
    v_cvt_f32_u32 v64, v64
    v_mul_f32 v64, 0x3b000000, v64
    v_cos_f32 v65, v64
    v_sin_f32 v66, v64
    s_nop 0
    v_sub_f32 v66, 0, v66
    v_mul_f32 v67, v31, v66
    v_mul_f32 v68, v31, v65
    v_fma_f32 v31, v30, v66, v68
    v_fma_f32 v30, v30, v65, -v67
    v_add_f32 v32, v16, v24
    v_add_f32 v33, v17, v25
    v_sub_f32 v34, v16, v24
    v_sub_f32 v35, v17, v25
    v_add_f32 v36, v20, v28
    v_add_f32 v37, v21, v29
    v_sub_f32 v38, v20, v28
    v_sub_f32 v39, v21, v29
    v_add_f32 v40, v18, v26
    v_add_f32 v41, v19, v27
    v_sub_f32 v42, v18, v26
    v_sub_f32 v43, v19, v27
    v_add_f32 v44, v22, v30
    v_add_f32 v45, v23, v31
    v_sub_f32 v46, v22, v30
    v_sub_f32 v47, v23, v31
    v_add_f32 v48, v32, v36
    v_add_f32 v49, v33, v37
    v_sub_f32 v52, v32, v36
    v_sub_f32 v53, v33, v37
    v_mov_b32 v16, v39
    v_sub_f32 v17, 0, v38
    v_add_f32 v50, v34, v16
    v_add_f32 v51, v35, v17
    v_sub_f32 v54, v34, v16
    v_sub_f32 v55, v35, v17
    v_add_f32 v56, v40, v44
    v_add_f32 v57, v41, v45
    v_sub_f32 v60, v40, v44
    v_sub_f32 v61, v41, v45
    v_mov_b32 v16, v47
    v_sub_f32 v17, 0, v46
    v_add_f32 v58, v42, v16
    v_add_f32 v59, v43, v17
    v_sub_f32 v62, v42, v16
    v_sub_f32 v63, v43, v17
    v_add_f32 v18, v58, v59
    v_sub_f32 v19, v59, v58
    v_mul_f32 v58, 0x3f3504f3, v18
    v_mul_f32 v59, 0x3f3504f3, v19
    v_sub_f32 v18, v62, v63
    v_add_f32 v19, v63, v62
    v_mul_f32 v62, 0xbf3504f3, v18
    v_mul_f32 v63, 0xbf3504f3, v19
    v_mov_b32 v20, v61
    v_sub_f32 v21, 0, v60
    v_mov_b32 v60, v20
    v_mov_b32 v61, v21
    v_add_f32 v16, v48, v56
    v_add_f32 v17, v49, v57
    v_sub_f32 v24, v48, v56
    v_sub_f32 v25, v49, v57
    v_add_f32 v18, v50, v58
    v_add_f32 v19, v51, v59
    v_sub_f32 v26, v50, v58
    v_sub_f32 v27, v51, v59
    v_add_f32 v20, v52, v60
    v_add_f32 v21, v53, v61
    v_sub_f32 v28, v52, v60
    v_sub_f32 v29, v53, v61
    v_add_f32 v22, v54, v62
    v_add_f32 v23, v55, v63
    v_sub_f32 v30, v54, v62
    v_sub_f32 v31, v55, v63
    v_lshlrev_b32 v6, 3, v7
    v_add_u32 v6, v6, v2
    ds_write_b64 v6, v[16:17] offset:0
    ds_write_b64 v6, v[18:19] offset:512
    ds_write_b64 v6, v[20:21] offset:1024
    ds_write_b64 v6, v[22:23] offset:1536
    ds_write_b64 v6, v[24:25] offset:2048
    ds_write_b64 v6, v[26:27] offset:2560
    ds_write_b64 v6, v[28:29] offset:3072
    ds_write_b64 v6, v[30:31] offset:3584
    s_waitcnt lgkmcnt(0)
    v_lshlrev_b32 v11, 4, v8
    v_add_u32 v4, 0, v1
    v_sub_u32 v5, 512, v4
    v_and_b32 v5, 511, v5
    v_lshlrev_b32 v6, 3, v4
    v_add_u32 v6, v6, v2
    v_lshlrev_b32 v7, 3, v5
    v_add_u32 v7, v7, v2
    ds_read_b64 v[16:17], v6
    ds_read_b64 v[18:19], v7
    s_waitcnt lgkmcnt(0)
    v_add_f32 v20, v16, v18
    v_sub_f32 v21, v17, v19
    v_add_f32 v22, v17, v19
    v_sub_f32 v23, v18, v16
    v_mul_f32 v20, 0.5, v20
    v_mul_f32 v21, 0.5, v21
    v_mul_f32 v22, 0.5, v22
    v_mul_f32 v23, 0.5, v23
    v_lshlrev_b32 v4, 14, v4
    v_add_u32 v4, v4, v11
    buffer_store_dwordx4 v[20:23], v4, s[8:11], 0 offen
    v_add_u32 v4, 64, v1
    v_sub_u32 v5, 512, v4
    v_and_b32 v5, 511, v5
    v_lshlrev_b32 v6, 3, v4
    v_add_u32 v6, v6, v2
    v_lshlrev_b32 v7, 3, v5
    v_add_u32 v7, v7, v2
    ds_read_b64 v[16:17], v6
    ds_read_b64 v[18:19], v7
    s_waitcnt lgkmcnt(0)
    v_add_f32 v20, v16, v18
    v_sub_f32 v21, v17, v19
    v_add_f32 v22, v17, v19
    v_sub_f32 v23, v18, v16
    v_mul_f32 v20, 0.5, v20
    v_mul_f32 v21, 0.5, v21
    v_mul_f32 v22, 0.5, v22
    v_mul_f32 v23, 0.5, v23
    v_lshlrev_b32 v4, 14, v4
    v_add_u32 v4, v4, v11
    buffer_store_dwordx4 v[20:23], v4, s[8:11], 0 offen
    v_add_u32 v4, 128, v1
    v_sub_u32 v5, 512, v4
    v_and_b32 v5, 511, v5
    v_lshlrev_b32 v6, 3, v4
    v_add_u32 v6, v6, v2
    v_lshlrev_b32 v7, 3, v5
    v_add_u32 v7, v7, v2
    ds_read_b64 v[16:17], v6
    ds_read_b64 v[18:19], v7
    s_waitcnt lgkmcnt(0)
    v_add_f32 v20, v16, v18
    v_sub_f32 v21, v17, v19
    v_add_f32 v22, v17, v19
    v_sub_f32 v23, v18, v16
    v_mul_f32 v20, 0.5, v20
    v_mul_f32 v21, 0.5, v21
    v_mul_f32 v22, 0.5, v22
    v_mul_f32 v23, 0.5, v23
    v_lshlrev_b32 v4, 14, v4
    v_add_u32 v4, v4, v11
    buffer_store_dwordx4 v[20:23], v4, s[8:11], 0 offen
    v_add_u32 v4, 192, v1
    v_sub_u32 v5, 512, v4
    v_and_b32 v5, 511, v5
    v_lshlrev_b32 v6, 3, v4
    v_add_u32 v6, v6, v2
    v_lshlrev_b32 v7, 3, v5
    v_add_u32 v7, v7, v2
    ds_read_b64 v[16:17], v6
    ds_read_b64 v[18:19], v7
    s_waitcnt lgkmcnt(0)
    v_add_f32 v20, v16, v18
    v_sub_f32 v21, v17, v19
    v_add_f32 v22, v17, v19
    v_sub_f32 v23, v18, v16
    v_mul_f32 v20, 0.5, v20
    v_mul_f32 v21, 0.5, v21
    v_mul_f32 v22, 0.5, v22
    v_mul_f32 v23, 0.5, v23
    v_lshlrev_b32 v4, 14, v4
    v_add_u32 v4, v4, v11
    buffer_store_dwordx4 v[20:23], v4, s[8:11], 0 offen
    v_add_u32 v4, 256, v1
    v_sub_u32 v5, 512, v4
    v_and_b32 v5, 511, v5
    v_lshlrev_b32 v6, 3, v4
    v_add_u32 v6, v6, v2
    v_lshlrev_b32 v7, 3, v5
    v_add_u32 v7, v7, v2
    ds_read_b64 v[16:17], v6
    ds_read_b64 v[18:19], v7
    s_waitcnt lgkmcnt(0)
    v_add_f32 v20, v16, v18
    v_sub_f32 v21, v17, v19
    v_add_f32 v22, v17, v19
    v_sub_f32 v23, v18, v16
    v_mul_f32 v20, 0.5, v20
    v_mul_f32 v21, 0.5, v21
    v_mul_f32 v22, 0.5, v22
    v_mul_f32 v23, 0.5, v23
    v_lshlrev_b32 v4, 14, v4
    v_add_u32 v4, v4, v11
    v_cmp_eq_u32 vcc, 0, v1
    s_and_saveexec_b64 s[12:13], vcc
    buffer_store_dwordx4 v[20:23], v4, s[8:11], 0 offen
    s_mov_b64 exec, s[12:13]
    s_endpgm
K1_TR:
    s_sub_u32 s3, s2, 256
    s_cmp_ge_u32 s3, 132
    s_cbranch_scc1 K1_END
    v_and_b32 v1, 63, v0
    v_lshrrev_b32 v8, 6, v0
    s_lshl_b32 s3, s3, 2
    v_add_u32 v8, s3, v8
    s_nop 0
    v_readfirstlane_b32 s3, v8
    s_cmp_ge_u32 s3, 352
    s_cbranch_scc1 K1_TD
    s_cmp_ge_u32 s3, 176
    s_cbranch_scc1 K1_TU
    s_mov_b32 s4, s24
    s_mov_b32 s5, s25
    s_and_b32 s5, s5, 0xffff
    s_mov_b32 s6, 0x158000
    s_mov_b32 s7, 0x20000
    s_add_u32 s8, s34, 0x1000000
    s_addc_u32 s9, s35, 0
    s_and_b32 s9, s9, 0xffff
    s_mov_b32 s10, 0x158000
    s_mov_b32 s11, 0x20000
    s_branch K1_TGU
K1_TU:
    s_sub_u32 s3, s3, 176
    s_mov_b32 s4, s26
    s_mov_b32 s5, s27
    s_and_b32 s5, s5, 0xffff
    s_mov_b32 s6, 0x158000
    s_mov_b32 s7, 0x20000
    s_add_u32 s8, s34, 0x1200000
    s_addc_u32 s9, s35, 0
    s_and_b32 s9, s9, 0xffff
    s_mov_b32 s10, 0x158000
    s_mov_b32 s11, 0x20000
K1_TGU:
    s_lshr_b32 s14, s3, 3
    s_and_b32 s15, s3, 7
    s_lshl_b32 s14, s14, 6
    s_lshl_b32 s15, s15, 6
    s_mov_b32 s36, 2752
    s_mov_b32 s37, 1024
    s_mov_b32 s38, 1376
    s_branch K1_TC
K1_TD:
    s_sub_u32 s3, s3, 352
    s_mov_b32 s4, s28
    s_mov_b32 s5, s29
    s_and_b32 s5, s5, 0xffff
    s_mov_b32 s6, 0x158000
    s_mov_b32 s7, 0x20000
    s_add_u32 s8, s34, 0x1400000
    s_addc_u32 s9, s35, 0
    s_and_b32 s9, s9, 0xffff
    s_mov_b32 s10, 0x160000
    s_mov_b32 s11, 0x20000
    s_and_b32 s14, s3, 7
    s_lshr_b32 s15, s3, 3
    s_lshl_b32 s14, s14, 6
    s_lshl_b32 s15, s15, 6
    s_mov_b32 s36, 1024
    s_mov_b32 s37, 2816
    s_mov_b32 s38, 512
K1_TC:
    v_add_u32 v2, s14, v1
    v_cmp_gt_u32 vcc, s38, v2
    s_and_saveexec_b64 s[12:13], vcc
    s_cbranch_execz K1_END
    s_add_u32 s39, s15, 0
    s_mul_i32 s40, s39, s36
    v_lshlrev_b32 v3, 1, v2
    v_add_u32 v3, s40, v3
    buffer_load_ushort v16, v3, s[4:7], 0 offen
    v_add_u32 v3, s36, v3
    buffer_load_ushort v17, v3, s[4:7], 0 offen
    v_add_u32 v3, s36, v3
    buffer_load_ushort v18, v3, s[4:7], 0 offen
    v_add_u32 v3, s36, v3
    buffer_load_ushort v19, v3, s[4:7], 0 offen
    v_add_u32 v3, s36, v3
    buffer_load_ushort v20, v3, s[4:7], 0 offen
    v_add_u32 v3, s36, v3
    buffer_load_ushort v21, v3, s[4:7], 0 offen
    v_add_u32 v3, s36, v3
    buffer_load_ushort v22, v3, s[4:7], 0 offen
    v_add_u32 v3, s36, v3
    buffer_load_ushort v23, v3, s[4:7], 0 offen
    v_add_u32 v3, s36, v3
    s_waitcnt vmcnt(0)
    v_lshl_or_b32 v24, v17, 16, v16
    v_lshl_or_b32 v25, v19, 16, v18
    v_lshl_or_b32 v26, v21, 16, v20
    v_lshl_or_b32 v27, v23, 16, v22
    v_mul_lo_u32 v3, v2, s37
    s_lshl_b32 s40, s39, 1
    v_add_u32 v3, s40, v3
    buffer_store_dwordx4 v[24:27], v3, s[8:11], 0 offen
    s_add_u32 s39, s15, 8
    s_mul_i32 s40, s39, s36
    v_lshlrev_b32 v3, 1, v2
    v_add_u32 v3, s40, v3
    buffer_load_ushort v16, v3, s[4:7], 0 offen
    v_add_u32 v3, s36, v3
    buffer_load_ushort v17, v3, s[4:7], 0 offen
    v_add_u32 v3, s36, v3
    buffer_load_ushort v18, v3, s[4:7], 0 offen
    v_add_u32 v3, s36, v3
    buffer_load_ushort v19, v3, s[4:7], 0 offen
    v_add_u32 v3, s36, v3
    buffer_load_ushort v20, v3, s[4:7], 0 offen
    v_add_u32 v3, s36, v3
    buffer_load_ushort v21, v3, s[4:7], 0 offen
    v_add_u32 v3, s36, v3
    buffer_load_ushort v22, v3, s[4:7], 0 offen
    v_add_u32 v3, s36, v3
    buffer_load_ushort v23, v3, s[4:7], 0 offen
    v_add_u32 v3, s36, v3
    s_waitcnt vmcnt(0)
    v_lshl_or_b32 v24, v17, 16, v16
    v_lshl_or_b32 v25, v19, 16, v18
    v_lshl_or_b32 v26, v21, 16, v20
    v_lshl_or_b32 v27, v23, 16, v22
    v_mul_lo_u32 v3, v2, s37
    s_lshl_b32 s40, s39, 1
    v_add_u32 v3, s40, v3
    buffer_store_dwordx4 v[24:27], v3, s[8:11], 0 offen
    s_add_u32 s39, s15, 16
    s_mul_i32 s40, s39, s36
    v_lshlrev_b32 v3, 1, v2
    v_add_u32 v3, s40, v3
    buffer_load_ushort v16, v3, s[4:7], 0 offen
    v_add_u32 v3, s36, v3
    buffer_load_ushort v17, v3, s[4:7], 0 offen
    v_add_u32 v3, s36, v3
    buffer_load_ushort v18, v3, s[4:7], 0 offen
    v_add_u32 v3, s36, v3
    buffer_load_ushort v19, v3, s[4:7], 0 offen
    v_add_u32 v3, s36, v3
    buffer_load_ushort v20, v3, s[4:7], 0 offen
    v_add_u32 v3, s36, v3
    buffer_load_ushort v21, v3, s[4:7], 0 offen
    v_add_u32 v3, s36, v3
    buffer_load_ushort v22, v3, s[4:7], 0 offen
    v_add_u32 v3, s36, v3
    buffer_load_ushort v23, v3, s[4:7], 0 offen
    v_add_u32 v3, s36, v3
    s_waitcnt vmcnt(0)
    v_lshl_or_b32 v24, v17, 16, v16
    v_lshl_or_b32 v25, v19, 16, v18
    v_lshl_or_b32 v26, v21, 16, v20
    v_lshl_or_b32 v27, v23, 16, v22
    v_mul_lo_u32 v3, v2, s37
    s_lshl_b32 s40, s39, 1
    v_add_u32 v3, s40, v3
    buffer_store_dwordx4 v[24:27], v3, s[8:11], 0 offen
    s_add_u32 s39, s15, 24
    s_mul_i32 s40, s39, s36
    v_lshlrev_b32 v3, 1, v2
    v_add_u32 v3, s40, v3
    buffer_load_ushort v16, v3, s[4:7], 0 offen
    v_add_u32 v3, s36, v3
    buffer_load_ushort v17, v3, s[4:7], 0 offen
    v_add_u32 v3, s36, v3
    buffer_load_ushort v18, v3, s[4:7], 0 offen
    v_add_u32 v3, s36, v3
    buffer_load_ushort v19, v3, s[4:7], 0 offen
    v_add_u32 v3, s36, v3
    buffer_load_ushort v20, v3, s[4:7], 0 offen
    v_add_u32 v3, s36, v3
    buffer_load_ushort v21, v3, s[4:7], 0 offen
    v_add_u32 v3, s36, v3
    buffer_load_ushort v22, v3, s[4:7], 0 offen
    v_add_u32 v3, s36, v3
    buffer_load_ushort v23, v3, s[4:7], 0 offen
    v_add_u32 v3, s36, v3
    s_waitcnt vmcnt(0)
    v_lshl_or_b32 v24, v17, 16, v16
    v_lshl_or_b32 v25, v19, 16, v18
    v_lshl_or_b32 v26, v21, 16, v20
    v_lshl_or_b32 v27, v23, 16, v22
    v_mul_lo_u32 v3, v2, s37
    s_lshl_b32 s40, s39, 1
    v_add_u32 v3, s40, v3
    buffer_store_dwordx4 v[24:27], v3, s[8:11], 0 offen
    s_add_u32 s39, s15, 32
    s_mul_i32 s40, s39, s36
    v_lshlrev_b32 v3, 1, v2
    v_add_u32 v3, s40, v3
    buffer_load_ushort v16, v3, s[4:7], 0 offen
    v_add_u32 v3, s36, v3
    buffer_load_ushort v17, v3, s[4:7], 0 offen
    v_add_u32 v3, s36, v3
    buffer_load_ushort v18, v3, s[4:7], 0 offen
    v_add_u32 v3, s36, v3
    buffer_load_ushort v19, v3, s[4:7], 0 offen
    v_add_u32 v3, s36, v3
    buffer_load_ushort v20, v3, s[4:7], 0 offen
    v_add_u32 v3, s36, v3
    buffer_load_ushort v21, v3, s[4:7], 0 offen
    v_add_u32 v3, s36, v3
    buffer_load_ushort v22, v3, s[4:7], 0 offen
    v_add_u32 v3, s36, v3
    buffer_load_ushort v23, v3, s[4:7], 0 offen
    v_add_u32 v3, s36, v3
    s_waitcnt vmcnt(0)
    v_lshl_or_b32 v24, v17, 16, v16
    v_lshl_or_b32 v25, v19, 16, v18
    v_lshl_or_b32 v26, v21, 16, v20
    v_lshl_or_b32 v27, v23, 16, v22
    v_mul_lo_u32 v3, v2, s37
    s_lshl_b32 s40, s39, 1
    v_add_u32 v3, s40, v3
    buffer_store_dwordx4 v[24:27], v3, s[8:11], 0 offen
    s_add_u32 s39, s15, 40
    s_mul_i32 s40, s39, s36
    v_lshlrev_b32 v3, 1, v2
    v_add_u32 v3, s40, v3
    buffer_load_ushort v16, v3, s[4:7], 0 offen
    v_add_u32 v3, s36, v3
    buffer_load_ushort v17, v3, s[4:7], 0 offen
    v_add_u32 v3, s36, v3
    buffer_load_ushort v18, v3, s[4:7], 0 offen
    v_add_u32 v3, s36, v3
    buffer_load_ushort v19, v3, s[4:7], 0 offen
    v_add_u32 v3, s36, v3
    buffer_load_ushort v20, v3, s[4:7], 0 offen
    v_add_u32 v3, s36, v3
    buffer_load_ushort v21, v3, s[4:7], 0 offen
    v_add_u32 v3, s36, v3
    buffer_load_ushort v22, v3, s[4:7], 0 offen
    v_add_u32 v3, s36, v3
    buffer_load_ushort v23, v3, s[4:7], 0 offen
    v_add_u32 v3, s36, v3
    s_waitcnt vmcnt(0)
    v_lshl_or_b32 v24, v17, 16, v16
    v_lshl_or_b32 v25, v19, 16, v18
    v_lshl_or_b32 v26, v21, 16, v20
    v_lshl_or_b32 v27, v23, 16, v22
    v_mul_lo_u32 v3, v2, s37
    s_lshl_b32 s40, s39, 1
    v_add_u32 v3, s40, v3
    buffer_store_dwordx4 v[24:27], v3, s[8:11], 0 offen
    s_add_u32 s39, s15, 48
    s_mul_i32 s40, s39, s36
    v_lshlrev_b32 v3, 1, v2
    v_add_u32 v3, s40, v3
    buffer_load_ushort v16, v3, s[4:7], 0 offen
    v_add_u32 v3, s36, v3
    buffer_load_ushort v17, v3, s[4:7], 0 offen
    v_add_u32 v3, s36, v3
    buffer_load_ushort v18, v3, s[4:7], 0 offen
    v_add_u32 v3, s36, v3
    buffer_load_ushort v19, v3, s[4:7], 0 offen
    v_add_u32 v3, s36, v3
    buffer_load_ushort v20, v3, s[4:7], 0 offen
    v_add_u32 v3, s36, v3
    buffer_load_ushort v21, v3, s[4:7], 0 offen
    v_add_u32 v3, s36, v3
    buffer_load_ushort v22, v3, s[4:7], 0 offen
    v_add_u32 v3, s36, v3
    buffer_load_ushort v23, v3, s[4:7], 0 offen
    v_add_u32 v3, s36, v3
    s_waitcnt vmcnt(0)
    v_lshl_or_b32 v24, v17, 16, v16
    v_lshl_or_b32 v25, v19, 16, v18
    v_lshl_or_b32 v26, v21, 16, v20
    v_lshl_or_b32 v27, v23, 16, v22
    v_mul_lo_u32 v3, v2, s37
    s_lshl_b32 s40, s39, 1
    v_add_u32 v3, s40, v3
    buffer_store_dwordx4 v[24:27], v3, s[8:11], 0 offen
    s_add_u32 s39, s15, 56
    s_mul_i32 s40, s39, s36
    v_lshlrev_b32 v3, 1, v2
    v_add_u32 v3, s40, v3
    buffer_load_ushort v16, v3, s[4:7], 0 offen
    v_add_u32 v3, s36, v3
    buffer_load_ushort v17, v3, s[4:7], 0 offen
    v_add_u32 v3, s36, v3
    buffer_load_ushort v18, v3, s[4:7], 0 offen
    v_add_u32 v3, s36, v3
    buffer_load_ushort v19, v3, s[4:7], 0 offen
    v_add_u32 v3, s36, v3
    buffer_load_ushort v20, v3, s[4:7], 0 offen
    v_add_u32 v3, s36, v3
    buffer_load_ushort v21, v3, s[4:7], 0 offen
    v_add_u32 v3, s36, v3
    buffer_load_ushort v22, v3, s[4:7], 0 offen
    v_add_u32 v3, s36, v3
    buffer_load_ushort v23, v3, s[4:7], 0 offen
    v_add_u32 v3, s36, v3
    s_waitcnt vmcnt(0)
    v_lshl_or_b32 v24, v17, 16, v16
    v_lshl_or_b32 v25, v19, 16, v18
    v_lshl_or_b32 v26, v21, 16, v20
    v_lshl_or_b32 v27, v23, 16, v22
    v_mul_lo_u32 v3, v2, s37
    s_lshl_b32 s40, s39, 1
    v_add_u32 v3, s40, v3
    buffer_store_dwordx4 v[24:27], v3, s[8:11], 0 offen
K1_END:
    s_endpgm
.globl k2_kernel
.p2align 8
.type k2_kernel,@function
k2_kernel:
    s_load_dwordx16 s[16:31], s[0:1], 0
    s_load_dwordx4 s[32:35], s[0:1], 64
    s_waitcnt lgkmcnt(0)
    s_cmp_ge_u32 s2, 257
    s_cbranch_scc1 K2_END
    s_mov_b32 s4, s34
    s_mov_b32 s5, s35
    s_and_b32 s5, s5, 0xffff
    s_mov_b32 s6, 0x404000
    s_mov_b32 s7, 0x20000
    s_mov_b32 s8, s18
    s_mov_b32 s9, s19
    s_and_b32 s9, s9, 0xffff
    s_mov_b32 s10, 0x101000
    s_mov_b32 s11, 0x20000
    s_mov_b32 s12, s20
    s_mov_b32 s13, s21
    s_and_b32 s13, s13, 0xffff
    s_mov_b32 s14, 0x101000
    s_mov_b32 s15, 0x20000
    s_lshl_b32 s3, s2, 14
    v_lshlrev_b32 v9, 3, v0
    v_add_u32 v9, s3, v9
    buffer_load_dwordx2 v[16:17], v9, s[4:7], 0 offen offset:0
    v_add_u32 v9, 2048, v9
    buffer_load_dwordx2 v[18:19], v9, s[4:7], 0 offen offset:0
    v_add_u32 v9, 2048, v9
    buffer_load_dwordx2 v[20:21], v9, s[4:7], 0 offen offset:0
    v_add_u32 v9, 2048, v9
    buffer_load_dwordx2 v[22:23], v9, s[4:7], 0 offen offset:0
    v_add_u32 v9, 2048, v9
    buffer_load_dwordx2 v[24:25], v9, s[4:7], 0 offen offset:0
    v_add_u32 v9, 2048, v9
    buffer_load_dwordx2 v[26:27], v9, s[4:7], 0 offen offset:0
    v_add_u32 v9, 2048, v9
    buffer_load_dwordx2 v[28:29], v9, s[4:7], 0 offen offset:0
    v_add_u32 v9, 2048, v9
    buffer_load_dwordx2 v[30:31], v9, s[4:7], 0 offen offset:0
    v_add_u32 v9, 2048, v9
    s_waitcnt vmcnt(0)
    v_add_f32 v32, v16, v24
    v_add_f32 v33, v17, v25
    v_sub_f32 v34, v16, v24
    v_sub_f32 v35, v17, v25
    v_add_f32 v36, v20, v28
    v_add_f32 v37, v21, v29
    v_sub_f32 v38, v20, v28
    v_sub_f32 v39, v21, v29
    v_add_f32 v40, v18, v26
    v_add_f32 v41, v19, v27
    v_sub_f32 v42, v18, v26
    v_sub_f32 v43, v19, v27
    v_add_f32 v44, v22, v30
    v_add_f32 v45, v23, v31
    v_sub_f32 v46, v22, v30
    v_sub_f32 v47, v23, v31
    v_add_f32 v48, v32, v36
    v_add_f32 v49, v33, v37
    v_sub_f32 v52, v32, v36
    v_sub_f32 v53, v33, v37
    v_mov_b32 v16, v39
    v_sub_f32 v17, 0, v38
    v_add_f32 v50, v34, v16
    v_add_f32 v51, v35, v17
    v_sub_f32 v54, v34, v16
    v_sub_f32 v55, v35, v17
    v_add_f32 v56, v40, v44
    v_add_f32 v57, v41, v45
    v_sub_f32 v60, v40, v44
    v_sub_f32 v61, v41, v45
    v_mov_b32 v16, v47
    v_sub_f32 v17, 0, v46
    v_add_f32 v58, v42, v16
    v_add_f32 v59, v43, v17
    v_sub_f32 v62, v42, v16
    v_sub_f32 v63, v43, v17
    v_add_f32 v18, v58, v59
    v_sub_f32 v19, v59, v58
    v_mul_f32 v58, 0x3f3504f3, v18
    v_mul_f32 v59, 0x3f3504f3, v19
    v_sub_f32 v18, v62, v63
    v_add_f32 v19, v63, v62
    v_mul_f32 v62, 0xbf3504f3, v18
    v_mul_f32 v63, 0xbf3504f3, v19
    v_mov_b32 v20, v61
    v_sub_f32 v21, 0, v60
    v_mov_b32 v60, v20
    v_mov_b32 v61, v21
    v_add_f32 v16, v48, v56
    v_add_f32 v17, v49, v57
    v_sub_f32 v24, v48, v56
    v_sub_f32 v25, v49, v57
    v_add_f32 v18, v50, v58
    v_add_f32 v19, v51, v59
    v_sub_f32 v26, v50, v58
    v_sub_f32 v27, v51, v59
    v_add_f32 v20, v52, v60
    v_add_f32 v21, v53, v61
    v_sub_f32 v28, v52, v60
    v_sub_f32 v29, v53, v61
    v_add_f32 v22, v54, v62
    v_add_f32 v23, v55, v63
    v_sub_f32 v30, v54, v62
    v_sub_f32 v31, v55, v63
    v_lshrrev_b32 v3, 0, v0
    v_lshlrev_b32 v3, 3, v3
    v_and_b32 v4, 0, v0
    v_add_u32 v3, v3, v4
    v_lshlrev_b32 v3, 3, v3
    ds_write_b64 v3, v[16:17] offset:0
    ds_write_b64 v3, v[18:19] offset:8
    ds_write_b64 v3, v[20:21] offset:16
    ds_write_b64 v3, v[22:23] offset:24
    ds_write_b64 v3, v[24:25] offset:32
    ds_write_b64 v3, v[26:27] offset:40
    ds_write_b64 v3, v[28:29] offset:48
    ds_write_b64 v3, v[30:31] offset:56
    s_waitcnt lgkmcnt(0)
    s_barrier
    v_lshlrev_b32 v3, 3, v0
    ds_read_b64 v[16:17], v3 offset:0
    ds_read_b64 v[18:19], v3 offset:2048
    ds_read_b64 v[20:21], v3 offset:4096
    ds_read_b64 v[22:23], v3 offset:6144
    ds_read_b64 v[24:25], v3 offset:8192
    ds_read_b64 v[26:27], v3 offset:10240
    ds_read_b64 v[28:29], v3 offset:12288
    ds_read_b64 v[30:31], v3 offset:14336
    v_and_b32 v4, 7, v0
    s_waitcnt lgkmcnt(0)
    v_mul_u32_u24 v64, 1, v4
    v_cvt_f32_u32 v64, v64
    v_mul_f32 v64, 0x3c800000, v64
    v_cos_f32 v65, v64
    v_sin_f32 v66, v64
    s_nop 0
    v_sub_f32 v66, 0, v66
    v_mul_f32 v67, v19, v66
    v_mul_f32 v68, v19, v65
    v_fma_f32 v19, v18, v66, v68
    v_fma_f32 v18, v18, v65, -v67
    v_mul_u32_u24 v64, 2, v4
    v_cvt_f32_u32 v64, v64
    v_mul_f32 v64, 0x3c800000, v64
    v_cos_f32 v65, v64
    v_sin_f32 v66, v64
    s_nop 0
    v_sub_f32 v66, 0, v66
    v_mul_f32 v67, v21, v66
    v_mul_f32 v68, v21, v65
    v_fma_f32 v21, v20, v66, v68
    v_fma_f32 v20, v20, v65, -v67
    v_mul_u32_u24 v64, 3, v4
    v_cvt_f32_u32 v64, v64
    v_mul_f32 v64, 0x3c800000, v64
    v_cos_f32 v65, v64
    v_sin_f32 v66, v64
    s_nop 0
    v_sub_f32 v66, 0, v66
    v_mul_f32 v67, v23, v66
    v_mul_f32 v68, v23, v65
    v_fma_f32 v23, v22, v66, v68
    v_fma_f32 v22, v22, v65, -v67
    v_mul_u32_u24 v64, 4, v4
    v_cvt_f32_u32 v64, v64
    v_mul_f32 v64, 0x3c800000, v64
    v_cos_f32 v65, v64
    v_sin_f32 v66, v64
    s_nop 0
    v_sub_f32 v66, 0, v66
    v_mul_f32 v67, v25, v66
    v_mul_f32 v68, v25, v65
    v_fma_f32 v25, v24, v66, v68
    v_fma_f32 v24, v24, v65, -v67
    v_mul_u32_u24 v64, 5, v4
    v_cvt_f32_u32 v64, v64
    v_mul_f32 v64, 0x3c800000, v64
    v_cos_f32 v65, v64
    v_sin_f32 v66, v64
    s_nop 0
    v_sub_f32 v66, 0, v66
    v_mul_f32 v67, v27, v66
    v_mul_f32 v68, v27, v65
    v_fma_f32 v27, v26, v66, v68
    v_fma_f32 v26, v26, v65, -v67
    v_mul_u32_u24 v64, 6, v4
    v_cvt_f32_u32 v64, v64
    v_mul_f32 v64, 0x3c800000, v64
    v_cos_f32 v65, v64
    v_sin_f32 v66, v64
    s_nop 0
    v_sub_f32 v66, 0, v66
    v_mul_f32 v67, v29, v66
    v_mul_f32 v68, v29, v65
    v_fma_f32 v29, v28, v66, v68
    v_fma_f32 v28, v28, v65, -v67
    v_mul_u32_u24 v64, 7, v4
    v_cvt_f32_u32 v64, v64
    v_mul_f32 v64, 0x3c800000, v64
    v_cos_f32 v65, v64
    v_sin_f32 v66, v64
    s_nop 0
    v_sub_f32 v66, 0, v66
    v_mul_f32 v67, v31, v66
    v_mul_f32 v68, v31, v65
    v_fma_f32 v31, v30, v66, v68
    v_fma_f32 v30, v30, v65, -v67
    v_add_f32 v32, v16, v24
    v_add_f32 v33, v17, v25
    v_sub_f32 v34, v16, v24
    v_sub_f32 v35, v17, v25
    v_add_f32 v36, v20, v28
    v_add_f32 v37, v21, v29
    v_sub_f32 v38, v20, v28
    v_sub_f32 v39, v21, v29
    v_add_f32 v40, v18, v26
    v_add_f32 v41, v19, v27
    v_sub_f32 v42, v18, v26
    v_sub_f32 v43, v19, v27
    v_add_f32 v44, v22, v30
    v_add_f32 v45, v23, v31
    v_sub_f32 v46, v22, v30
    v_sub_f32 v47, v23, v31
    v_add_f32 v48, v32, v36
    v_add_f32 v49, v33, v37
    v_sub_f32 v52, v32, v36
    v_sub_f32 v53, v33, v37
    v_mov_b32 v16, v39
    v_sub_f32 v17, 0, v38
    v_add_f32 v50, v34, v16
    v_add_f32 v51, v35, v17
    v_sub_f32 v54, v34, v16
    v_sub_f32 v55, v35, v17
    v_add_f32 v56, v40, v44
    v_add_f32 v57, v41, v45
    v_sub_f32 v60, v40, v44
    v_sub_f32 v61, v41, v45
    v_mov_b32 v16, v47
    v_sub_f32 v17, 0, v46
    v_add_f32 v58, v42, v16
    v_add_f32 v59, v43, v17
    v_sub_f32 v62, v42, v16
    v_sub_f32 v63, v43, v17
    v_add_f32 v18, v58, v59
    v_sub_f32 v19, v59, v58
    v_mul_f32 v58, 0x3f3504f3, v18
    v_mul_f32 v59, 0x3f3504f3, v19
    v_sub_f32 v18, v62, v63
    v_add_f32 v19, v63, v62
    v_mul_f32 v62, 0xbf3504f3, v18
    v_mul_f32 v63, 0xbf3504f3, v19
    v_mov_b32 v20, v61
    v_sub_f32 v21, 0, v60
    v_mov_b32 v60, v20
    v_mov_b32 v61, v21
    v_add_f32 v16, v48, v56
    v_add_f32 v17, v49, v57
    v_sub_f32 v24, v48, v56
    v_sub_f32 v25, v49, v57
    v_add_f32 v18, v50, v58
    v_add_f32 v19, v51, v59
    v_sub_f32 v26, v50, v58
    v_sub_f32 v27, v51, v59
    v_add_f32 v20, v52, v60
    v_add_f32 v21, v53, v61
    v_sub_f32 v28, v52, v60
    v_sub_f32 v29, v53, v61
    v_add_f32 v22, v54, v62
    v_add_f32 v23, v55, v63
    v_sub_f32 v30, v54, v62
    v_sub_f32 v31, v55, v63
    v_lshrrev_b32 v3, 3, v0
    v_lshlrev_b32 v3, 6, v3
    v_and_b32 v4, 7, v0
    v_add_u32 v3, v3, v4
    v_lshlrev_b32 v3, 3, v3
    ds_write_b64 v3, v[16:17] offset:16384
    ds_write_b64 v3, v[18:19] offset:16448
    ds_write_b64 v3, v[20:21] offset:16512
    ds_write_b64 v3, v[22:23] offset:16576
    ds_write_b64 v3, v[24:25] offset:16640
    ds_write_b64 v3, v[26:27] offset:16704
    ds_write_b64 v3, v[28:29] offset:16768
    ds_write_b64 v3, v[30:31] offset:16832
    s_waitcnt lgkmcnt(0)
    s_barrier
    v_lshlrev_b32 v3, 3, v0
    ds_read_b64 v[16:17], v3 offset:16384
    ds_read_b64 v[18:19], v3 offset:18432
    ds_read_b64 v[20:21], v3 offset:20480
    ds_read_b64 v[22:23], v3 offset:22528
    ds_read_b64 v[24:25], v3 offset:24576
    ds_read_b64 v[26:27], v3 offset:26624
    ds_read_b64 v[28:29], v3 offset:28672
    ds_read_b64 v[30:31], v3 offset:30720
    v_and_b32 v4, 63, v0
    s_waitcnt lgkmcnt(0)
    v_mul_u32_u24 v64, 1, v4
    v_cvt_f32_u32 v64, v64
    v_mul_f32 v64, 0x3b000000, v64
    v_cos_f32 v65, v64
    v_sin_f32 v66, v64
    s_nop 0
    v_sub_f32 v66, 0, v66
    v_mul_f32 v67, v19, v66
    v_mul_f32 v68, v19, v65
    v_fma_f32 v19, v18, v66, v68
    v_fma_f32 v18, v18, v65, -v67
    v_mul_u32_u24 v64, 2, v4
    v_cvt_f32_u32 v64, v64
    v_mul_f32 v64, 0x3b000000, v64
    v_cos_f32 v65, v64
    v_sin_f32 v66, v64
    s_nop 0
    v_sub_f32 v66, 0, v66
    v_mul_f32 v67, v21, v66
    v_mul_f32 v68, v21, v65
    v_fma_f32 v21, v20, v66, v68
    v_fma_f32 v20, v20, v65, -v67
    v_mul_u32_u24 v64, 3, v4
    v_cvt_f32_u32 v64, v64
    v_mul_f32 v64, 0x3b000000, v64
    v_cos_f32 v65, v64
    v_sin_f32 v66, v64
    s_nop 0
    v_sub_f32 v66, 0, v66
    v_mul_f32 v67, v23, v66
    v_mul_f32 v68, v23, v65
    v_fma_f32 v23, v22, v66, v68
    v_fma_f32 v22, v22, v65, -v67
    v_mul_u32_u24 v64, 4, v4
    v_cvt_f32_u32 v64, v64
    v_mul_f32 v64, 0x3b000000, v64
    v_cos_f32 v65, v64
    v_sin_f32 v66, v64
    s_nop 0
    v_sub_f32 v66, 0, v66
    v_mul_f32 v67, v25, v66
    v_mul_f32 v68, v25, v65
    v_fma_f32 v25, v24, v66, v68
    v_fma_f32 v24, v24, v65, -v67
    v_mul_u32_u24 v64, 5, v4
    v_cvt_f32_u32 v64, v64
    v_mul_f32 v64, 0x3b000000, v64
    v_cos_f32 v65, v64
    v_sin_f32 v66, v64
    s_nop 0
    v_sub_f32 v66, 0, v66
    v_mul_f32 v67, v27, v66
    v_mul_f32 v68, v27, v65
    v_fma_f32 v27, v26, v66, v68
    v_fma_f32 v26, v26, v65, -v67
    v_mul_u32_u24 v64, 6, v4
    v_cvt_f32_u32 v64, v64
    v_mul_f32 v64, 0x3b000000, v64
    v_cos_f32 v65, v64
    v_sin_f32 v66, v64
    s_nop 0
    v_sub_f32 v66, 0, v66
    v_mul_f32 v67, v29, v66
    v_mul_f32 v68, v29, v65
    v_fma_f32 v29, v28, v66, v68
    v_fma_f32 v28, v28, v65, -v67
    v_mul_u32_u24 v64, 7, v4
    v_cvt_f32_u32 v64, v64
    v_mul_f32 v64, 0x3b000000, v64
    v_cos_f32 v65, v64
    v_sin_f32 v66, v64
    s_nop 0
    v_sub_f32 v66, 0, v66
    v_mul_f32 v67, v31, v66
    v_mul_f32 v68, v31, v65
    v_fma_f32 v31, v30, v66, v68
    v_fma_f32 v30, v30, v65, -v67
    v_add_f32 v32, v16, v24
    v_add_f32 v33, v17, v25
    v_sub_f32 v34, v16, v24
    v_sub_f32 v35, v17, v25
    v_add_f32 v36, v20, v28
    v_add_f32 v37, v21, v29
    v_sub_f32 v38, v20, v28
    v_sub_f32 v39, v21, v29
    v_add_f32 v40, v18, v26
    v_add_f32 v41, v19, v27
    v_sub_f32 v42, v18, v26
    v_sub_f32 v43, v19, v27
    v_add_f32 v44, v22, v30
    v_add_f32 v45, v23, v31
    v_sub_f32 v46, v22, v30
    v_sub_f32 v47, v23, v31
    v_add_f32 v48, v32, v36
    v_add_f32 v49, v33, v37
    v_sub_f32 v52, v32, v36
    v_sub_f32 v53, v33, v37
    v_mov_b32 v16, v39
    v_sub_f32 v17, 0, v38
    v_add_f32 v50, v34, v16
    v_add_f32 v51, v35, v17
    v_sub_f32 v54, v34, v16
    v_sub_f32 v55, v35, v17
    v_add_f32 v56, v40, v44
    v_add_f32 v57, v41, v45
    v_sub_f32 v60, v40, v44
    v_sub_f32 v61, v41, v45
    v_mov_b32 v16, v47
    v_sub_f32 v17, 0, v46
    v_add_f32 v58, v42, v16
    v_add_f32 v59, v43, v17
    v_sub_f32 v62, v42, v16
    v_sub_f32 v63, v43, v17
    v_add_f32 v18, v58, v59
    v_sub_f32 v19, v59, v58
    v_mul_f32 v58, 0x3f3504f3, v18
    v_mul_f32 v59, 0x3f3504f3, v19
    v_sub_f32 v18, v62, v63
    v_add_f32 v19, v63, v62
    v_mul_f32 v62, 0xbf3504f3, v18
    v_mul_f32 v63, 0xbf3504f3, v19
    v_mov_b32 v20, v61
    v_sub_f32 v21, 0, v60
    v_mov_b32 v60, v20
    v_mov_b32 v61, v21
    v_add_f32 v16, v48, v56
    v_add_f32 v17, v49, v57
    v_sub_f32 v24, v48, v56
    v_sub_f32 v25, v49, v57
    v_add_f32 v18, v50, v58
    v_add_f32 v19, v51, v59
    v_sub_f32 v26, v50, v58
    v_sub_f32 v27, v51, v59
    v_add_f32 v20, v52, v60
    v_add_f32 v21, v53, v61
    v_sub_f32 v28, v52, v60
    v_sub_f32 v29, v53, v61
    v_add_f32 v22, v54, v62
    v_add_f32 v23, v55, v63
    v_sub_f32 v30, v54, v62
    v_sub_f32 v31, v55, v63
    v_lshrrev_b32 v3, 6, v0
    v_lshlrev_b32 v3, 9, v3
    v_and_b32 v4, 63, v0
    v_add_u32 v3, v3, v4
    v_lshlrev_b32 v3, 3, v3
    ds_write_b64 v3, v[16:17] offset:0
    ds_write_b64 v3, v[18:19] offset:512
    ds_write_b64 v3, v[20:21] offset:1024
    ds_write_b64 v3, v[22:23] offset:1536
    ds_write_b64 v3, v[24:25] offset:2048
    ds_write_b64 v3, v[26:27] offset:2560
    ds_write_b64 v3, v[28:29] offset:3072
    ds_write_b64 v3, v[30:31] offset:3584
    s_waitcnt lgkmcnt(0)
    s_barrier
    v_lshlrev_b32 v3, 3, v0
    ds_read_b64 v[16:17], v3 offset:0
    ds_read_b64 v[18:19], v3 offset:2048
    ds_read_b64 v[20:21], v3 offset:4096
    ds_read_b64 v[22:23], v3 offset:6144
    ds_read_b64 v[24:25], v3 offset:8192
    ds_read_b64 v[26:27], v3 offset:10240
    ds_read_b64 v[28:29], v3 offset:12288
    ds_read_b64 v[30:31], v3 offset:14336
    s_waitcnt lgkmcnt(0)
    v_add_u32 v4, 0, v0
    v_mul_u32_u24 v64, 1, v4
    v_cvt_f32_u32 v64, v64
    v_mul_f32 v64, 0x3a000000, v64
    v_cos_f32 v65, v64
    v_sin_f32 v66, v64
    s_nop 0
    v_sub_f32 v66, 0, v66
    v_mul_f32 v67, v21, v66
    v_mul_f32 v68, v21, v65
    v_fma_f32 v21, v20, v66, v68
    v_fma_f32 v20, v20, v65, -v67
    v_mul_u32_u24 v64, 2, v4
    v_cvt_f32_u32 v64, v64
    v_mul_f32 v64, 0x3a000000, v64
    v_cos_f32 v65, v64
    v_sin_f32 v66, v64
    s_nop 0
    v_sub_f32 v66, 0, v66
    v_mul_f32 v67, v25, v66
    v_mul_f32 v68, v25, v65
    v_fma_f32 v25, v24, v66, v68
    v_fma_f32 v24, v24, v65, -v67
    v_mul_u32_u24 v64, 3, v4
    v_cvt_f32_u32 v64, v64
    v_mul_f32 v64, 0x3a000000, v64
    v_cos_f32 v65, v64
    v_sin_f32 v66, v64
    s_nop 0
    v_sub_f32 v66, 0, v66
    v_mul_f32 v67, v29, v66
    v_mul_f32 v68, v29, v65
    v_fma_f32 v29, v28, v66, v68
    v_fma_f32 v28, v28, v65, -v67
    v_add_f32 v32, v16, v24
    v_add_f32 v33, v17, v25
    v_sub_f32 v34, v16, v24
    v_sub_f32 v35, v17, v25
    v_add_f32 v36, v20, v28
    v_add_f32 v37, v21, v29
    v_sub_f32 v38, v20, v28
    v_sub_f32 v39, v21, v29
    v_mov_b32 v20, v39
    v_sub_f32 v21, 0, v38
    v_add_f32 v16, v32, v36
    v_add_f32 v17, v33, v37
    v_sub_f32 v24, v32, v36
    v_sub_f32 v25, v33, v37
    v_sub_f32 v28, v34, v20
    v_sub_f32 v29, v35, v21
    v_add_f32 v20, v34, v20
    v_add_f32 v21, v35, v21
    v_add_u32 v4, 256, v0
    v_mul_u32_u24 v64, 1, v4
    v_cvt_f32_u32 v64, v64
    v_mul_f32 v64, 0x3a000000, v64
    v_cos_f32 v65, v64
    v_sin_f32 v66, v64
    s_nop 0
    v_sub_f32 v66, 0, v66
    v_mul_f32 v67, v23, v66
    v_mul_f32 v68, v23, v65
    v_fma_f32 v23, v22, v66, v68
    v_fma_f32 v22, v22, v65, -v67
    v_mul_u32_u24 v64, 2, v4
    v_cvt_f32_u32 v64, v64
    v_mul_f32 v64, 0x3a000000, v64
    v_cos_f32 v65, v64
    v_sin_f32 v66, v64
    s_nop 0
    v_sub_f32 v66, 0, v66
    v_mul_f32 v67, v27, v66
    v_mul_f32 v68, v27, v65
    v_fma_f32 v27, v26, v66, v68
    v_fma_f32 v26, v26, v65, -v67
    v_mul_u32_u24 v64, 3, v4
    v_cvt_f32_u32 v64, v64
    v_mul_f32 v64, 0x3a000000, v64
    v_cos_f32 v65, v64
    v_sin_f32 v66, v64
    s_nop 0
    v_sub_f32 v66, 0, v66
    v_mul_f32 v67, v31, v66
    v_mul_f32 v68, v31, v65
    v_fma_f32 v31, v30, v66, v68
    v_fma_f32 v30, v30, v65, -v67
    v_add_f32 v32, v18, v26
    v_add_f32 v33, v19, v27
    v_sub_f32 v34, v18, v26
    v_sub_f32 v35, v19, v27
    v_add_f32 v36, v22, v30
    v_add_f32 v37, v23, v31
    v_sub_f32 v38, v22, v30
    v_sub_f32 v39, v23, v31
    v_mov_b32 v22, v39
    v_sub_f32 v23, 0, v38
    v_add_f32 v18, v32, v36
    v_add_f32 v19, v33, v37
    v_sub_f32 v26, v32, v36
    v_sub_f32 v27, v33, v37
    v_sub_f32 v30, v34, v22
    v_sub_f32 v31, v35, v23
    v_add_f32 v22, v34, v22
    v_add_f32 v23, v35, v23
    v_mul_u32_u24 v5, 514, v0
    s_lshl_b32 s3, s2, 1
    v_add_u32 v5, s3, v5
    buffer_load_ushort v72, v5, s[8:11], 0 offen
    buffer_load_ushort v73, v5, s[12:15], 0 offen
    v_add_u32 v5, 131584, v5
    buffer_load_ushort v74, v5, s[8:11], 0 offen
    buffer_load_ushort v75, v5, s[12:15], 0 offen
    v_add_u32 v5, 131584, v5
    buffer_load_ushort v76, v5, s[8:11], 0 offen
    buffer_load_ushort v77, v5, s[12:15], 0 offen
    v_add_u32 v5, 131584, v5
    buffer_load_ushort v78, v5, s[8:11], 0 offen
    buffer_load_ushort v79, v5, s[12:15], 0 offen
    v_add_u32 v5, 131584, v5
    buffer_load_ushort v80, v5, s[8:11], 0 offen
    buffer_load_ushort v81, v5, s[12:15], 0 offen
    v_add_u32 v5, 131584, v5
    buffer_load_ushort v82, v5, s[8:11], 0 offen
    buffer_load_ushort v83, v5, s[12:15], 0 offen
    v_add_u32 v5, 131584, v5
    buffer_load_ushort v84, v5, s[8:11], 0 offen
    buffer_load_ushort v85, v5, s[12:15], 0 offen
    v_add_u32 v5, 131584, v5
    buffer_load_ushort v86, v5, s[8:11], 0 offen
    buffer_load_ushort v87, v5, s[12:15], 0 offen
    v_add_u32 v5, 131584, v5
    s_waitcnt vmcnt(0)
    v_lshlrev_b32 v72, 16, v72
    v_lshlrev_b32 v73, 16, v73
    v_mul_f32 v67, v17, v73
    v_mul_f32 v68, v17, v72
    v_fma_f32 v17, v16, v73, v68
    v_fma_f32 v16, v16, v72, -v67
    v_lshlrev_b32 v74, 16, v74
    v_lshlrev_b32 v75, 16, v75
    v_mul_f32 v67, v19, v75
    v_mul_f32 v68, v19, v74
    v_fma_f32 v19, v18, v75, v68
    v_fma_f32 v18, v18, v74, -v67
    v_lshlrev_b32 v76, 16, v76
    v_lshlrev_b32 v77, 16, v77
    v_mul_f32 v67, v21, v77
    v_mul_f32 v68, v21, v76
    v_fma_f32 v21, v20, v77, v68
    v_fma_f32 v20, v20, v76, -v67
    v_lshlrev_b32 v78, 16, v78
    v_lshlrev_b32 v79, 16, v79
    v_mul_f32 v67, v23, v79
    v_mul_f32 v68, v23, v78
    v_fma_f32 v23, v22, v79, v68
    v_fma_f32 v22, v22, v78, -v67
    v_lshlrev_b32 v80, 16, v80
    v_lshlrev_b32 v81, 16, v81
    v_mul_f32 v67, v25, v81
    v_mul_f32 v68, v25, v80
    v_fma_f32 v25, v24, v81, v68
    v_fma_f32 v24, v24, v80, -v67
    v_lshlrev_b32 v82, 16, v82
    v_lshlrev_b32 v83, 16, v83
    v_mul_f32 v67, v27, v83
    v_mul_f32 v68, v27, v82
    v_fma_f32 v27, v26, v83, v68
    v_fma_f32 v26, v26, v82, -v67
    v_lshlrev_b32 v84, 16, v84
    v_lshlrev_b32 v85, 16, v85
    v_mul_f32 v67, v29, v85
    v_mul_f32 v68, v29, v84
    v_fma_f32 v29, v28, v85, v68
    v_fma_f32 v28, v28, v84, -v67
    v_lshlrev_b32 v86, 16, v86
    v_lshlrev_b32 v87, 16, v87
    v_mul_f32 v67, v31, v87
    v_mul_f32 v68, v31, v86
    v_fma_f32 v31, v30, v87, v68
    v_fma_f32 v30, v30, v86, -v67
    s_barrier
    v_add_f32 v32, v16, v24
    v_add_f32 v33, v17, v25
    v_sub_f32 v34, v16, v24
    v_sub_f32 v35, v17, v25
    v_add_f32 v36, v20, v28
    v_add_f32 v37, v21, v29
    v_sub_f32 v38, v20, v28
    v_sub_f32 v39, v21, v29
    v_add_f32 v40, v18, v26
    v_add_f32 v41, v19, v27
    v_sub_f32 v42, v18, v26
    v_sub_f32 v43, v19, v27
    v_add_f32 v44, v22, v30
    v_add_f32 v45, v23, v31
    v_sub_f32 v46, v22, v30
    v_sub_f32 v47, v23, v31
    v_add_f32 v48, v32, v36
    v_add_f32 v49, v33, v37
    v_sub_f32 v52, v32, v36
    v_sub_f32 v53, v33, v37
    v_sub_f32 v16, 0, v39
    v_mov_b32 v17, v38
    v_add_f32 v50, v34, v16
    v_add_f32 v51, v35, v17
    v_sub_f32 v54, v34, v16
    v_sub_f32 v55, v35, v17
    v_add_f32 v56, v40, v44
    v_add_f32 v57, v41, v45
    v_sub_f32 v60, v40, v44
    v_sub_f32 v61, v41, v45
    v_sub_f32 v16, 0, v47
    v_mov_b32 v17, v46
    v_add_f32 v58, v42, v16
    v_add_f32 v59, v43, v17
    v_sub_f32 v62, v42, v16
    v_sub_f32 v63, v43, v17
    v_sub_f32 v18, v58, v59
    v_add_f32 v19, v59, v58
    v_mul_f32 v58, 0x3f3504f3, v18
    v_mul_f32 v59, 0x3f3504f3, v19
    v_add_f32 v18, v62, v63
    v_sub_f32 v19, v63, v62
    v_mul_f32 v62, 0xbf3504f3, v18
    v_mul_f32 v63, 0xbf3504f3, v19
    v_sub_f32 v20, 0, v61
    v_mov_b32 v21, v60
    v_mov_b32 v60, v20
    v_mov_b32 v61, v21
    v_add_f32 v16, v48, v56
    v_add_f32 v17, v49, v57
    v_sub_f32 v24, v48, v56
    v_sub_f32 v25, v49, v57
    v_add_f32 v18, v50, v58
    v_add_f32 v19, v51, v59
    v_sub_f32 v26, v50, v58
    v_sub_f32 v27, v51, v59
    v_add_f32 v20, v52, v60
    v_add_f32 v21, v53, v61
    v_sub_f32 v28, v52, v60
    v_sub_f32 v29, v53, v61
    v_add_f32 v22, v54, v62
    v_add_f32 v23, v55, v63
    v_sub_f32 v30, v54, v62
    v_sub_f32 v31, v55, v63
    v_lshrrev_b32 v3, 0, v0
    v_lshlrev_b32 v3, 3, v3
    v_and_b32 v4, 0, v0
    v_add_u32 v3, v3, v4
    v_lshlrev_b32 v3, 3, v3
    ds_write_b64 v3, v[16:17] offset:0
    ds_write_b64 v3, v[18:19] offset:8
    ds_write_b64 v3, v[20:21] offset:16
    ds_write_b64 v3, v[22:23] offset:24
    ds_write_b64 v3, v[24:25] offset:32
    ds_write_b64 v3, v[26:27] offset:40
    ds_write_b64 v3, v[28:29] offset:48
    ds_write_b64 v3, v[30:31] offset:56
    s_waitcnt lgkmcnt(0)
    s_barrier
    v_lshlrev_b32 v3, 3, v0
    ds_read_b64 v[16:17], v3 offset:0
    ds_read_b64 v[18:19], v3 offset:2048
    ds_read_b64 v[20:21], v3 offset:4096
    ds_read_b64 v[22:23], v3 offset:6144
    ds_read_b64 v[24:25], v3 offset:8192
    ds_read_b64 v[26:27], v3 offset:10240
    ds_read_b64 v[28:29], v3 offset:12288
    ds_read_b64 v[30:31], v3 offset:14336
    v_and_b32 v4, 7, v0
    s_waitcnt lgkmcnt(0)
    v_mul_u32_u24 v64, 1, v4
    v_cvt_f32_u32 v64, v64
    v_mul_f32 v64, 0x3c800000, v64
    v_cos_f32 v65, v64
    v_sin_f32 v66, v64
    s_nop 0
    v_mul_f32 v67, v19, v66
    v_mul_f32 v68, v19, v65
    v_fma_f32 v19, v18, v66, v68
    v_fma_f32 v18, v18, v65, -v67
    v_mul_u32_u24 v64, 2, v4
    v_cvt_f32_u32 v64, v64
    v_mul_f32 v64, 0x3c800000, v64
    v_cos_f32 v65, v64
    v_sin_f32 v66, v64
    s_nop 0
    v_mul_f32 v67, v21, v66
    v_mul_f32 v68, v21, v65
    v_fma_f32 v21, v20, v66, v68
    v_fma_f32 v20, v20, v65, -v67
    v_mul_u32_u24 v64, 3, v4
    v_cvt_f32_u32 v64, v64
    v_mul_f32 v64, 0x3c800000, v64
    v_cos_f32 v65, v64
    v_sin_f32 v66, v64
    s_nop 0
    v_mul_f32 v67, v23, v66
    v_mul_f32 v68, v23, v65
    v_fma_f32 v23, v22, v66, v68
    v_fma_f32 v22, v22, v65, -v67
    v_mul_u32_u24 v64, 4, v4
    v_cvt_f32_u32 v64, v64
    v_mul_f32 v64, 0x3c800000, v64
    v_cos_f32 v65, v64
    v_sin_f32 v66, v64
    s_nop 0
    v_mul_f32 v67, v25, v66
    v_mul_f32 v68, v25, v65
    v_fma_f32 v25, v24, v66, v68
    v_fma_f32 v24, v24, v65, -v67
    v_mul_u32_u24 v64, 5, v4
    v_cvt_f32_u32 v64, v64
    v_mul_f32 v64, 0x3c800000, v64
    v_cos_f32 v65, v64
    v_sin_f32 v66, v64
    s_nop 0
    v_mul_f32 v67, v27, v66
    v_mul_f32 v68, v27, v65
    v_fma_f32 v27, v26, v66, v68
    v_fma_f32 v26, v26, v65, -v67
    v_mul_u32_u24 v64, 6, v4
    v_cvt_f32_u32 v64, v64
    v_mul_f32 v64, 0x3c800000, v64
    v_cos_f32 v65, v64
    v_sin_f32 v66, v64
    s_nop 0
    v_mul_f32 v67, v29, v66
    v_mul_f32 v68, v29, v65
    v_fma_f32 v29, v28, v66, v68
    v_fma_f32 v28, v28, v65, -v67
    v_mul_u32_u24 v64, 7, v4
    v_cvt_f32_u32 v64, v64
    v_mul_f32 v64, 0x3c800000, v64
    v_cos_f32 v65, v64
    v_sin_f32 v66, v64
    s_nop 0
    v_mul_f32 v67, v31, v66
    v_mul_f32 v68, v31, v65
    v_fma_f32 v31, v30, v66, v68
    v_fma_f32 v30, v30, v65, -v67
    v_add_f32 v32, v16, v24
    v_add_f32 v33, v17, v25
    v_sub_f32 v34, v16, v24
    v_sub_f32 v35, v17, v25
    v_add_f32 v36, v20, v28
    v_add_f32 v37, v21, v29
    v_sub_f32 v38, v20, v28
    v_sub_f32 v39, v21, v29
    v_add_f32 v40, v18, v26
    v_add_f32 v41, v19, v27
    v_sub_f32 v42, v18, v26
    v_sub_f32 v43, v19, v27
    v_add_f32 v44, v22, v30
    v_add_f32 v45, v23, v31
    v_sub_f32 v46, v22, v30
    v_sub_f32 v47, v23, v31
    v_add_f32 v48, v32, v36
    v_add_f32 v49, v33, v37
    v_sub_f32 v52, v32, v36
    v_sub_f32 v53, v33, v37
    v_sub_f32 v16, 0, v39
    v_mov_b32 v17, v38
    v_add_f32 v50, v34, v16
    v_add_f32 v51, v35, v17
    v_sub_f32 v54, v34, v16
    v_sub_f32 v55, v35, v17
    v_add_f32 v56, v40, v44
    v_add_f32 v57, v41, v45
    v_sub_f32 v60, v40, v44
    v_sub_f32 v61, v41, v45
    v_sub_f32 v16, 0, v47
    v_mov_b32 v17, v46
    v_add_f32 v58, v42, v16
    v_add_f32 v59, v43, v17
    v_sub_f32 v62, v42, v16
    v_sub_f32 v63, v43, v17
    v_sub_f32 v18, v58, v59
    v_add_f32 v19, v59, v58
    v_mul_f32 v58, 0x3f3504f3, v18
    v_mul_f32 v59, 0x3f3504f3, v19
    v_add_f32 v18, v62, v63
    v_sub_f32 v19, v63, v62
    v_mul_f32 v62, 0xbf3504f3, v18
    v_mul_f32 v63, 0xbf3504f3, v19
    v_sub_f32 v20, 0, v61
    v_mov_b32 v21, v60
    v_mov_b32 v60, v20
    v_mov_b32 v61, v21
    v_add_f32 v16, v48, v56
    v_add_f32 v17, v49, v57
    v_sub_f32 v24, v48, v56
    v_sub_f32 v25, v49, v57
    v_add_f32 v18, v50, v58
    v_add_f32 v19, v51, v59
    v_sub_f32 v26, v50, v58
    v_sub_f32 v27, v51, v59
    v_add_f32 v20, v52, v60
    v_add_f32 v21, v53, v61
    v_sub_f32 v28, v52, v60
    v_sub_f32 v29, v53, v61
    v_add_f32 v22, v54, v62
    v_add_f32 v23, v55, v63
    v_sub_f32 v30, v54, v62
    v_sub_f32 v31, v55, v63
    v_lshrrev_b32 v3, 3, v0
    v_lshlrev_b32 v3, 6, v3
    v_and_b32 v4, 7, v0
    v_add_u32 v3, v3, v4
    v_lshlrev_b32 v3, 3, v3
    ds_write_b64 v3, v[16:17] offset:16384
    ds_write_b64 v3, v[18:19] offset:16448
    ds_write_b64 v3, v[20:21] offset:16512
    ds_write_b64 v3, v[22:23] offset:16576
    ds_write_b64 v3, v[24:25] offset:16640
    ds_write_b64 v3, v[26:27] offset:16704
    ds_write_b64 v3, v[28:29] offset:16768
    ds_write_b64 v3, v[30:31] offset:16832
    s_waitcnt lgkmcnt(0)
    s_barrier
    v_lshlrev_b32 v3, 3, v0
    ds_read_b64 v[16:17], v3 offset:16384
    ds_read_b64 v[18:19], v3 offset:18432
    ds_read_b64 v[20:21], v3 offset:20480
    ds_read_b64 v[22:23], v3 offset:22528
    ds_read_b64 v[24:25], v3 offset:24576
    ds_read_b64 v[26:27], v3 offset:26624
    ds_read_b64 v[28:29], v3 offset:28672
    ds_read_b64 v[30:31], v3 offset:30720
    v_and_b32 v4, 63, v0
    s_waitcnt lgkmcnt(0)
    v_mul_u32_u24 v64, 1, v4
    v_cvt_f32_u32 v64, v64
    v_mul_f32 v64, 0x3b000000, v64
    v_cos_f32 v65, v64
    v_sin_f32 v66, v64
    s_nop 0
    v_mul_f32 v67, v19, v66
    v_mul_f32 v68, v19, v65
    v_fma_f32 v19, v18, v66, v68
    v_fma_f32 v18, v18, v65, -v67
    v_mul_u32_u24 v64, 2, v4
    v_cvt_f32_u32 v64, v64
    v_mul_f32 v64, 0x3b000000, v64
    v_cos_f32 v65, v64
    v_sin_f32 v66, v64
    s_nop 0
    v_mul_f32 v67, v21, v66
    v_mul_f32 v68, v21, v65
    v_fma_f32 v21, v20, v66, v68
    v_fma_f32 v20, v20, v65, -v67
    v_mul_u32_u24 v64, 3, v4
    v_cvt_f32_u32 v64, v64
    v_mul_f32 v64, 0x3b000000, v64
    v_cos_f32 v65, v64
    v_sin_f32 v66, v64
    s_nop 0
    v_mul_f32 v67, v23, v66
    v_mul_f32 v68, v23, v65
    v_fma_f32 v23, v22, v66, v68
    v_fma_f32 v22, v22, v65, -v67
    v_mul_u32_u24 v64, 4, v4
    v_cvt_f32_u32 v64, v64
    v_mul_f32 v64, 0x3b000000, v64
    v_cos_f32 v65, v64
    v_sin_f32 v66, v64
    s_nop 0
    v_mul_f32 v67, v25, v66
    v_mul_f32 v68, v25, v65
    v_fma_f32 v25, v24, v66, v68
    v_fma_f32 v24, v24, v65, -v67
    v_mul_u32_u24 v64, 5, v4
    v_cvt_f32_u32 v64, v64
    v_mul_f32 v64, 0x3b000000, v64
    v_cos_f32 v65, v64
    v_sin_f32 v66, v64
    s_nop 0
    v_mul_f32 v67, v27, v66
    v_mul_f32 v68, v27, v65
    v_fma_f32 v27, v26, v66, v68
    v_fma_f32 v26, v26, v65, -v67
    v_mul_u32_u24 v64, 6, v4
    v_cvt_f32_u32 v64, v64
    v_mul_f32 v64, 0x3b000000, v64
    v_cos_f32 v65, v64
    v_sin_f32 v66, v64
    s_nop 0
    v_mul_f32 v67, v29, v66
    v_mul_f32 v68, v29, v65
    v_fma_f32 v29, v28, v66, v68
    v_fma_f32 v28, v28, v65, -v67
    v_mul_u32_u24 v64, 7, v4
    v_cvt_f32_u32 v64, v64
    v_mul_f32 v64, 0x3b000000, v64
    v_cos_f32 v65, v64
    v_sin_f32 v66, v64
    s_nop 0
    v_mul_f32 v67, v31, v66
    v_mul_f32 v68, v31, v65
    v_fma_f32 v31, v30, v66, v68
    v_fma_f32 v30, v30, v65, -v67
    v_add_f32 v32, v16, v24
    v_add_f32 v33, v17, v25
    v_sub_f32 v34, v16, v24
    v_sub_f32 v35, v17, v25
    v_add_f32 v36, v20, v28
    v_add_f32 v37, v21, v29
    v_sub_f32 v38, v20, v28
    v_sub_f32 v39, v21, v29
    v_add_f32 v40, v18, v26
    v_add_f32 v41, v19, v27
    v_sub_f32 v42, v18, v26
    v_sub_f32 v43, v19, v27
    v_add_f32 v44, v22, v30
    v_add_f32 v45, v23, v31
    v_sub_f32 v46, v22, v30
    v_sub_f32 v47, v23, v31
    v_add_f32 v48, v32, v36
    v_add_f32 v49, v33, v37
    v_sub_f32 v52, v32, v36
    v_sub_f32 v53, v33, v37
    v_sub_f32 v16, 0, v39
    v_mov_b32 v17, v38
    v_add_f32 v50, v34, v16
    v_add_f32 v51, v35, v17
    v_sub_f32 v54, v34, v16
    v_sub_f32 v55, v35, v17
    v_add_f32 v56, v40, v44
    v_add_f32 v57, v41, v45
    v_sub_f32 v60, v40, v44
    v_sub_f32 v61, v41, v45
    v_sub_f32 v16, 0, v47
    v_mov_b32 v17, v46
    v_add_f32 v58, v42, v16
    v_add_f32 v59, v43, v17
    v_sub_f32 v62, v42, v16
    v_sub_f32 v63, v43, v17
    v_sub_f32 v18, v58, v59
    v_add_f32 v19, v59, v58
    v_mul_f32 v58, 0x3f3504f3, v18
    v_mul_f32 v59, 0x3f3504f3, v19
    v_add_f32 v18, v62, v63
    v_sub_f32 v19, v63, v62
    v_mul_f32 v62, 0xbf3504f3, v18
    v_mul_f32 v63, 0xbf3504f3, v19
    v_sub_f32 v20, 0, v61
    v_mov_b32 v21, v60
    v_mov_b32 v60, v20
    v_mov_b32 v61, v21
    v_add_f32 v16, v48, v56
    v_add_f32 v17, v49, v57
    v_sub_f32 v24, v48, v56
    v_sub_f32 v25, v49, v57
    v_add_f32 v18, v50, v58
    v_add_f32 v19, v51, v59
    v_sub_f32 v26, v50, v58
    v_sub_f32 v27, v51, v59
    v_add_f32 v20, v52, v60
    v_add_f32 v21, v53, v61
    v_sub_f32 v28, v52, v60
    v_sub_f32 v29, v53, v61
    v_add_f32 v22, v54, v62
    v_add_f32 v23, v55, v63
    v_sub_f32 v30, v54, v62
    v_sub_f32 v31, v55, v63
    v_lshrrev_b32 v3, 6, v0
    v_lshlrev_b32 v3, 9, v3
    v_and_b32 v4, 63, v0
    v_add_u32 v3, v3, v4
    v_lshlrev_b32 v3, 3, v3
    ds_write_b64 v3, v[16:17] offset:0
    ds_write_b64 v3, v[18:19] offset:512
    ds_write_b64 v3, v[20:21] offset:1024
    ds_write_b64 v3, v[22:23] offset:1536
    ds_write_b64 v3, v[24:25] offset:2048
    ds_write_b64 v3, v[26:27] offset:2560
    ds_write_b64 v3, v[28:29] offset:3072
    ds_write_b64 v3, v[30:31] offset:3584
    s_waitcnt lgkmcnt(0)
    s_barrier
    v_lshlrev_b32 v3, 3, v0
    ds_read_b64 v[16:17], v3 offset:0
    ds_read_b64 v[18:19], v3 offset:2048
    ds_read_b64 v[20:21], v3 offset:4096
    ds_read_b64 v[22:23], v3 offset:6144
    ds_read_b64 v[24:25], v3 offset:8192
    ds_read_b64 v[26:27], v3 offset:10240
    ds_read_b64 v[28:29], v3 offset:12288
    ds_read_b64 v[30:31], v3 offset:14336
    s_waitcnt lgkmcnt(0)
    v_add_u32 v4, 0, v0
    v_mul_u32_u24 v64, 1, v4
    v_cvt_f32_u32 v64, v64
    v_mul_f32 v64, 0x3a000000, v64
    v_cos_f32 v65, v64
    v_sin_f32 v66, v64
    s_nop 0
    v_mul_f32 v67, v21, v66
    v_mul_f32 v68, v21, v65
    v_fma_f32 v21, v20, v66, v68
    v_fma_f32 v20, v20, v65, -v67
    v_mul_u32_u24 v64, 2, v4
    v_cvt_f32_u32 v64, v64
    v_mul_f32 v64, 0x3a000000, v64
    v_cos_f32 v65, v64
    v_sin_f32 v66, v64
    s_nop 0
    v_mul_f32 v67, v25, v66
    v_mul_f32 v68, v25, v65
    v_fma_f32 v25, v24, v66, v68
    v_fma_f32 v24, v24, v65, -v67
    v_mul_u32_u24 v64, 3, v4
    v_cvt_f32_u32 v64, v64
    v_mul_f32 v64, 0x3a000000, v64
    v_cos_f32 v65, v64
    v_sin_f32 v66, v64
    s_nop 0
    v_mul_f32 v67, v29, v66
    v_mul_f32 v68, v29, v65
    v_fma_f32 v29, v28, v66, v68
    v_fma_f32 v28, v28, v65, -v67
    v_add_f32 v32, v16, v24
    v_add_f32 v33, v17, v25
    v_sub_f32 v34, v16, v24
    v_sub_f32 v35, v17, v25
    v_add_f32 v36, v20, v28
    v_add_f32 v37, v21, v29
    v_sub_f32 v38, v20, v28
    v_sub_f32 v39, v21, v29
    v_sub_f32 v20, 0, v39
    v_mov_b32 v21, v38
    v_add_f32 v16, v32, v36
    v_add_f32 v17, v33, v37
    v_sub_f32 v24, v32, v36
    v_sub_f32 v25, v33, v37
    v_sub_f32 v28, v34, v20
    v_sub_f32 v29, v35, v21
    v_add_f32 v20, v34, v20
    v_add_f32 v21, v35, v21
    v_add_u32 v4, 256, v0
    v_mul_u32_u24 v64, 1, v4
    v_cvt_f32_u32 v64, v64
    v_mul_f32 v64, 0x3a000000, v64
    v_cos_f32 v65, v64
    v_sin_f32 v66, v64
    s_nop 0
    v_mul_f32 v67, v23, v66
    v_mul_f32 v68, v23, v65
    v_fma_f32 v23, v22, v66, v68
    v_fma_f32 v22, v22, v65, -v67
    v_mul_u32_u24 v64, 2, v4
    v_cvt_f32_u32 v64, v64
    v_mul_f32 v64, 0x3a000000, v64
    v_cos_f32 v65, v64
    v_sin_f32 v66, v64
    s_nop 0
    v_mul_f32 v67, v27, v66
    v_mul_f32 v68, v27, v65
    v_fma_f32 v27, v26, v66, v68
    v_fma_f32 v26, v26, v65, -v67
    v_mul_u32_u24 v64, 3, v4
    v_cvt_f32_u32 v64, v64
    v_mul_f32 v64, 0x3a000000, v64
    v_cos_f32 v65, v64
    v_sin_f32 v66, v64
    s_nop 0
    v_mul_f32 v67, v31, v66
    v_mul_f32 v68, v31, v65
    v_fma_f32 v31, v30, v66, v68
    v_fma_f32 v30, v30, v65, -v67
    v_add_f32 v32, v18, v26
    v_add_f32 v33, v19, v27
    v_sub_f32 v34, v18, v26
    v_sub_f32 v35, v19, v27
    v_add_f32 v36, v22, v30
    v_add_f32 v37, v23, v31
    v_sub_f32 v38, v22, v30
    v_sub_f32 v39, v23, v31
    v_sub_f32 v22, 0, v39
    v_mov_b32 v23, v38
    v_add_f32 v18, v32, v36
    v_add_f32 v19, v33, v37
    v_sub_f32 v26, v32, v36
    v_sub_f32 v27, v33, v37
    v_sub_f32 v30, v34, v22
    v_sub_f32 v31, v35, v23
    v_add_f32 v22, v34, v22
    v_add_f32 v23, v35, v23
    s_lshl_b32 s3, s2, 14
    v_lshlrev_b32 v9, 3, v0
    v_add_u32 v9, s3, v9
    v_mul_f32 v16, 0x35800000, v16
    v_mul_f32 v17, 0x35800000, v17
    buffer_store_dwordx2 v[16:17], v9, s[4:7], 0 offen
    v_add_u32 v9, 2048, v9
    v_mul_f32 v18, 0x35800000, v18
    v_mul_f32 v19, 0x35800000, v19
    buffer_store_dwordx2 v[18:19], v9, s[4:7], 0 offen
    v_add_u32 v9, 2048, v9
    v_mul_f32 v20, 0x35800000, v20
    v_mul_f32 v21, 0x35800000, v21
    buffer_store_dwordx2 v[20:21], v9, s[4:7], 0 offen
    v_add_u32 v9, 2048, v9
    v_mul_f32 v22, 0x35800000, v22
    v_mul_f32 v23, 0x35800000, v23
    buffer_store_dwordx2 v[22:23], v9, s[4:7], 0 offen
    v_add_u32 v9, 2048, v9
    v_mul_f32 v24, 0x35800000, v24
    v_mul_f32 v25, 0x35800000, v25
    buffer_store_dwordx2 v[24:25], v9, s[4:7], 0 offen
    v_add_u32 v9, 2048, v9
    v_mul_f32 v26, 0x35800000, v26
    v_mul_f32 v27, 0x35800000, v27
    buffer_store_dwordx2 v[26:27], v9, s[4:7], 0 offen
    v_add_u32 v9, 2048, v9
    v_mul_f32 v28, 0x35800000, v28
    v_mul_f32 v29, 0x35800000, v29
    buffer_store_dwordx2 v[28:29], v9, s[4:7], 0 offen
    v_add_u32 v9, 2048, v9
    v_mul_f32 v30, 0x35800000, v30
    v_mul_f32 v31, 0x35800000, v31
    buffer_store_dwordx2 v[30:31], v9, s[4:7], 0 offen
    v_add_u32 v9, 2048, v9
K2_END:
    s_endpgm
.globl k3_kernel
.p2align 8
.type k3_kernel,@function
k3_kernel:
    s_load_dwordx16 s[16:31], s[0:1], 0
    s_load_dwordx4 s[32:35], s[0:1], 64
    s_waitcnt lgkmcnt(0)
    s_cmp_ge_u32 s2, 256
    s_cbranch_scc1 K3_END
    s_mov_b32 s4, s16
    s_mov_b32 s5, s17
    s_and_b32 s5, s5, 0xffff
    s_mov_b32 s6, 0x200000
    s_mov_b32 s7, 0x20000
    s_mov_b32 s8, s34
    s_mov_b32 s9, s35
    s_and_b32 s9, s9, 0xffff
    s_mov_b32 s10, 0x404000
    s_mov_b32 s11, 0x20000
    s_add_u32 s12, s34, 0x500000
    s_addc_u32 s13, s35, 0
    s_and_b32 s13, s13, 0xffff
    s_mov_b32 s14, 0x200000
    s_mov_b32 s15, 0x20000
    s_add_u32 s40, s34, 0x700000
    s_addc_u32 s41, s35, 0
    s_and_b32 s41, s41, 0xffff
    s_mov_b32 s42, 0x200000
    s_mov_b32 s43, 0x20000
    v_and_b32 v1, 63, v0
    v_lshrrev_b32 v8, 6, v0
    v_mul_u32_u24 v2, 4608, v8
    s_lshl_b32 s3, s2, 2
    v_add_u32 v8, s3, v8
    v_lshlrev_b32 v11, 4, v8
    v_add_u32 v4, 0, v1
    v_lshlrev_b32 v5, 14, v4
    v_add_u32 v5, v5, v11
    buffer_load_dwordx4 v[16:19], v5, s[8:11], 0 offen
    s_waitcnt vmcnt(0)
    v_sub_f32 v20, v16, v19
    v_add_f32 v21, v17, v18
    v_add_f32 v22, v16, v19
    v_sub_f32 v23, v18, v17
    v_lshlrev_b32 v6, 3, v4
    v_add_u32 v6, v6, v2
    v_sub_u32 v7, 512, v4
    v_lshlrev_b32 v7, 3, v7
    v_add_u32 v7, v7, v2
    v_and_b32 v5, 255, v4
    v_cmp_eq_u32 vcc, 0, v5
    s_nop 1
    v_cndmask_b32 v20, v20, v16, vcc
    v_cndmask_b32 v21, v21, v18, vcc
    s_mov_b64 s[38:39], vcc
    ds_write_b64 v6, v[20:21]
    s_mov_b64 s[36:37], exec
    s_andn2_b64 exec, exec, s[38:39]
    ds_write_b64 v7, v[22:23]
    s_mov_b64 exec, s[36:37]
    v_add_u32 v4, 64, v1
    v_lshlrev_b32 v5, 14, v4
    v_add_u32 v5, v5, v11
    buffer_load_dwordx4 v[16:19], v5, s[8:11], 0 offen
    s_waitcnt vmcnt(0)
    v_sub_f32 v20, v16, v19
    v_add_f32 v21, v17, v18
    v_add_f32 v22, v16, v19
    v_sub_f32 v23, v18, v17
    v_lshlrev_b32 v6, 3, v4
    v_add_u32 v6, v6, v2
    v_sub_u32 v7, 512, v4
    v_lshlrev_b32 v7, 3, v7
    v_add_u32 v7, v7, v2
    ds_write_b64 v6, v[20:21]
    ds_write_b64 v7, v[22:23]
    v_add_u32 v4, 128, v1
    v_lshlrev_b32 v5, 14, v4
    v_add_u32 v5, v5, v11
    buffer_load_dwordx4 v[16:19], v5, s[8:11], 0 offen
    s_waitcnt vmcnt(0)
    v_sub_f32 v20, v16, v19
    v_add_f32 v21, v17, v18
    v_add_f32 v22, v16, v19
    v_sub_f32 v23, v18, v17
    v_lshlrev_b32 v6, 3, v4
    v_add_u32 v6, v6, v2
    v_sub_u32 v7, 512, v4
    v_lshlrev_b32 v7, 3, v7
    v_add_u32 v7, v7, v2
    ds_write_b64 v6, v[20:21]
    ds_write_b64 v7, v[22:23]
    v_add_u32 v4, 192, v1
    v_lshlrev_b32 v5, 14, v4
    v_add_u32 v5, v5, v11
    buffer_load_dwordx4 v[16:19], v5, s[8:11], 0 offen
    s_waitcnt vmcnt(0)
    v_sub_f32 v20, v16, v19
    v_add_f32 v21, v17, v18
    v_add_f32 v22, v16, v19
    v_sub_f32 v23, v18, v17
    v_lshlrev_b32 v6, 3, v4
    v_add_u32 v6, v6, v2
    v_sub_u32 v7, 512, v4
    v_lshlrev_b32 v7, 3, v7
    v_add_u32 v7, v7, v2
    ds_write_b64 v6, v[20:21]
    ds_write_b64 v7, v[22:23]
    v_add_u32 v4, 256, v1
    v_lshlrev_b32 v5, 14, v4
    v_add_u32 v5, v5, v11
    buffer_load_dwordx4 v[16:19], v5, s[8:11], 0 offen
    s_waitcnt vmcnt(0)
    v_sub_f32 v20, v16, v19
    v_add_f32 v21, v17, v18
    v_add_f32 v22, v16, v19
    v_sub_f32 v23, v18, v17
    v_lshlrev_b32 v6, 3, v4
    v_add_u32 v6, v6, v2
    v_sub_u32 v7, 512, v4
    v_lshlrev_b32 v7, 3, v7
    v_add_u32 v7, v7, v2
    v_and_b32 v5, 255, v4
    v_cmp_eq_u32 vcc, 0, v5
    s_nop 1
    v_cndmask_b32 v20, v20, v16, vcc
    v_cndmask_b32 v21, v21, v18, vcc
    s_and_saveexec_b64 s[36:37], vcc
    ds_write_b64 v6, v[20:21]
    s_mov_b64 exec, s[36:37]
    s_waitcnt lgkmcnt(0)
    v_lshlrev_b32 v3, 3, v1
    v_add_u32 v3, v3, v2
    ds_read_b64 v[16:17], v3 offset:0
    ds_read_b64 v[18:19], v3 offset:512
    ds_read_b64 v[20:21], v3 offset:1024
    ds_read_b64 v[22:23], v3 offset:1536
    ds_read_b64 v[24:25], v3 offset:2048
    ds_read_b64 v[26:27], v3 offset:2560
    ds_read_b64 v[28:29], v3 offset:3072
    ds_read_b64 v[30:31], v3 offset:3584
    s_waitcnt lgkmcnt(0)
    v_add_f32 v32, v16, v24
    v_add_f32 v33, v17, v25
    v_sub_f32 v34, v16, v24
    v_sub_f32 v35, v17, v25
    v_add_f32 v36, v20, v28
    v_add_f32 v37, v21, v29
    v_sub_f32 v38, v20, v28
    v_sub_f32 v39, v21, v29
    v_add_f32 v40, v18, v26
    v_add_f32 v41, v19, v27
    v_sub_f32 v42, v18, v26
    v_sub_f32 v43, v19, v27
    v_add_f32 v44, v22, v30
    v_add_f32 v45, v23, v31
    v_sub_f32 v46, v22, v30
    v_sub_f32 v47, v23, v31
    v_add_f32 v48, v32, v36
    v_add_f32 v49, v33, v37
    v_sub_f32 v52, v32, v36
    v_sub_f32 v53, v33, v37
    v_sub_f32 v16, 0, v39
    v_mov_b32 v17, v38
    v_add_f32 v50, v34, v16
    v_add_f32 v51, v35, v17
    v_sub_f32 v54, v34, v16
    v_sub_f32 v55, v35, v17
    v_add_f32 v56, v40, v44
    v_add_f32 v57, v41, v45
    v_sub_f32 v60, v40, v44
    v_sub_f32 v61, v41, v45
    v_sub_f32 v16, 0, v47
    v_mov_b32 v17, v46
    v_add_f32 v58, v42, v16
    v_add_f32 v59, v43, v17
    v_sub_f32 v62, v42, v16
    v_sub_f32 v63, v43, v17
    v_sub_f32 v18, v58, v59
    v_add_f32 v19, v59, v58
    v_mul_f32 v58, 0x3f3504f3, v18
    v_mul_f32 v59, 0x3f3504f3, v19
    v_add_f32 v18, v62, v63
    v_sub_f32 v19, v63, v62
    v_mul_f32 v62, 0xbf3504f3, v18
    v_mul_f32 v63, 0xbf3504f3, v19
    v_sub_f32 v20, 0, v61
    v_mov_b32 v21, v60
    v_mov_b32 v60, v20
    v_mov_b32 v61, v21
    v_add_f32 v16, v48, v56
    v_add_f32 v17, v49, v57
    v_sub_f32 v24, v48, v56
    v_sub_f32 v25, v49, v57
    v_add_f32 v18, v50, v58
    v_add_f32 v19, v51, v59
    v_sub_f32 v26, v50, v58
    v_sub_f32 v27, v51, v59
    v_add_f32 v20, v52, v60
    v_add_f32 v21, v53, v61
    v_sub_f32 v28, v52, v60
    v_sub_f32 v29, v53, v61
    v_add_f32 v22, v54, v62
    v_add_f32 v23, v55, v63
    v_sub_f32 v30, v54, v62
    v_sub_f32 v31, v55, v63
    v_lshlrev_b32 v3, 3, v1
    v_add_u32 v3, v3, v2
    ds_write_b64 v3, v[16:17] offset:0
    ds_write_b64 v3, v[18:19] offset:512
    ds_write_b64 v3, v[20:21] offset:1024
    ds_write_b64 v3, v[22:23] offset:1536
    ds_write_b64 v3, v[24:25] offset:2048
    ds_write_b64 v3, v[26:27] offset:2560
    ds_write_b64 v3, v[28:29] offset:3072
    ds_write_b64 v3, v[30:31] offset:3584
    v_lshrrev_b32 v4, 3, v1
    v_and_b32 v5, 7, v1
    v_lshlrev_b32 v6, 9, v4
    v_lshlrev_b32 v7, 3, v5
    v_add_u32 v6, v6, v7
    v_add_u32 v6, v6, v2
    s_waitcnt lgkmcnt(0)
    ds_read_b64 v[16:17], v6 offset:0
    ds_read_b64 v[18:19], v6 offset:64
    ds_read_b64 v[20:21], v6 offset:128
    ds_read_b64 v[22:23], v6 offset:192
    ds_read_b64 v[24:25], v6 offset:256
    ds_read_b64 v[26:27], v6 offset:320
    ds_read_b64 v[28:29], v6 offset:384
    ds_read_b64 v[30:31], v6 offset:448
    s_waitcnt lgkmcnt(0)
    v_mul_u32_u24 v64, 1, v4
    v_cvt_f32_u32 v64, v64
    v_mul_f32 v64, 0x3c800000, v64
    v_cos_f32 v65, v64
    v_sin_f32 v66, v64
    s_nop 0
    v_mul_f32 v67, v19, v66
    v_mul_f32 v68, v19, v65
    v_fma_f32 v19, v18, v66, v68
    v_fma_f32 v18, v18, v65, -v67
    v_mul_u32_u24 v64, 2, v4
    v_cvt_f32_u32 v64, v64
    v_mul_f32 v64, 0x3c800000, v64
    v_cos_f32 v65, v64
    v_sin_f32 v66, v64
    s_nop 0
    v_mul_f32 v67, v21, v66
    v_mul_f32 v68, v21, v65
    v_fma_f32 v21, v20, v66, v68
    v_fma_f32 v20, v20, v65, -v67
    v_mul_u32_u24 v64, 3, v4
    v_cvt_f32_u32 v64, v64
    v_mul_f32 v64, 0x3c800000, v64
    v_cos_f32 v65, v64
    v_sin_f32 v66, v64
    s_nop 0
    v_mul_f32 v67, v23, v66
    v_mul_f32 v68, v23, v65
    v_fma_f32 v23, v22, v66, v68
    v_fma_f32 v22, v22, v65, -v67
    v_mul_u32_u24 v64, 4, v4
    v_cvt_f32_u32 v64, v64
    v_mul_f32 v64, 0x3c800000, v64
    v_cos_f32 v65, v64
    v_sin_f32 v66, v64
    s_nop 0
    v_mul_f32 v67, v25, v66
    v_mul_f32 v68, v25, v65
    v_fma_f32 v25, v24, v66, v68
    v_fma_f32 v24, v24, v65, -v67
    v_mul_u32_u24 v64, 5, v4
    v_cvt_f32_u32 v64, v64
    v_mul_f32 v64, 0x3c800000, v64
    v_cos_f32 v65, v64
    v_sin_f32 v66, v64
    s_nop 0
    v_mul_f32 v67, v27, v66
    v_mul_f32 v68, v27, v65
    v_fma_f32 v27, v26, v66, v68
    v_fma_f32 v26, v26, v65, -v67
    v_mul_u32_u24 v64, 6, v4
    v_cvt_f32_u32 v64, v64
    v_mul_f32 v64, 0x3c800000, v64
    v_cos_f32 v65, v64
    v_sin_f32 v66, v64
    s_nop 0
    v_mul_f32 v67, v29, v66
    v_mul_f32 v68, v29, v65
    v_fma_f32 v29, v28, v66, v68
    v_fma_f32 v28, v28, v65, -v67
    v_mul_u32_u24 v64, 7, v4
    v_cvt_f32_u32 v64, v64
    v_mul_f32 v64, 0x3c800000, v64
    v_cos_f32 v65, v64
    v_sin_f32 v66, v64
    s_nop 0
    v_mul_f32 v67, v31, v66
    v_mul_f32 v68, v31, v65
    v_fma_f32 v31, v30, v66, v68
    v_fma_f32 v30, v30, v65, -v67
    v_add_f32 v32, v16, v24
    v_add_f32 v33, v17, v25
    v_sub_f32 v34, v16, v24
    v_sub_f32 v35, v17, v25
    v_add_f32 v36, v20, v28
    v_add_f32 v37, v21, v29
    v_sub_f32 v38, v20, v28
    v_sub_f32 v39, v21, v29
    v_add_f32 v40, v18, v26
    v_add_f32 v41, v19, v27
    v_sub_f32 v42, v18, v26
    v_sub_f32 v43, v19, v27
    v_add_f32 v44, v22, v30
    v_add_f32 v45, v23, v31
    v_sub_f32 v46, v22, v30
    v_sub_f32 v47, v23, v31
    v_add_f32 v48, v32, v36
    v_add_f32 v49, v33, v37
    v_sub_f32 v52, v32, v36
    v_sub_f32 v53, v33, v37
    v_sub_f32 v16, 0, v39
    v_mov_b32 v17, v38
    v_add_f32 v50, v34, v16
    v_add_f32 v51, v35, v17
    v_sub_f32 v54, v34, v16
    v_sub_f32 v55, v35, v17
    v_add_f32 v56, v40, v44
    v_add_f32 v57, v41, v45
    v_sub_f32 v60, v40, v44
    v_sub_f32 v61, v41, v45
    v_sub_f32 v16, 0, v47
    v_mov_b32 v17, v46
    v_add_f32 v58, v42, v16
    v_add_f32 v59, v43, v17
    v_sub_f32 v62, v42, v16
    v_sub_f32 v63, v43, v17
    v_sub_f32 v18, v58, v59
    v_add_f32 v19, v59, v58
    v_mul_f32 v58, 0x3f3504f3, v18
    v_mul_f32 v59, 0x3f3504f3, v19
    v_add_f32 v18, v62, v63
    v_sub_f32 v19, v63, v62
    v_mul_f32 v62, 0xbf3504f3, v18
    v_mul_f32 v63, 0xbf3504f3, v19
    v_sub_f32 v20, 0, v61
    v_mov_b32 v21, v60
    v_mov_b32 v60, v20
    v_mov_b32 v61, v21
    v_add_f32 v16, v48, v56
    v_add_f32 v17, v49, v57
    v_sub_f32 v24, v48, v56
    v_sub_f32 v25, v49, v57
    v_add_f32 v18, v50, v58
    v_add_f32 v19, v51, v59
    v_sub_f32 v26, v50, v58
    v_sub_f32 v27, v51, v59
    v_add_f32 v20, v52, v60
    v_add_f32 v21, v53, v61
    v_sub_f32 v28, v52, v60
    v_sub_f32 v29, v53, v61
    v_add_f32 v22, v54, v62
    v_add_f32 v23, v55, v63
    v_sub_f32 v30, v54, v62
    v_sub_f32 v31, v55, v63
    ds_write_b64 v6, v[16:17] offset:0
    ds_write_b64 v6, v[18:19] offset:64
    ds_write_b64 v6, v[20:21] offset:128
    ds_write_b64 v6, v[22:23] offset:192
    ds_write_b64 v6, v[24:25] offset:256
    ds_write_b64 v6, v[26:27] offset:320
    ds_write_b64 v6, v[28:29] offset:384
    ds_write_b64 v6, v[30:31] offset:448
    v_lshlrev_b32 v6, 6, v1
    v_add_u32 v6, v6, v2
    s_waitcnt lgkmcnt(0)
    ds_read_b64 v[16:17], v6 offset:0
    ds_read_b64 v[18:19], v6 offset:8
    ds_read_b64 v[20:21], v6 offset:16
    ds_read_b64 v[22:23], v6 offset:24
    ds_read_b64 v[24:25], v6 offset:32
    ds_read_b64 v[26:27], v6 offset:40
    ds_read_b64 v[28:29], v6 offset:48
    ds_read_b64 v[30:31], v6 offset:56
    v_lshlrev_b32 v7, 3, v5
    v_add_u32 v7, v7, v4
    s_waitcnt lgkmcnt(0)
    v_mul_u32_u24 v64, 1, v7
    v_cvt_f32_u32 v64, v64
    v_mul_f32 v64, 0x3b000000, v64
    v_cos_f32 v65, v64
    v_sin_f32 v66, v64
    s_nop 0
    v_mul_f32 v67, v19, v66
    v_mul_f32 v68, v19, v65
    v_fma_f32 v19, v18, v66, v68
    v_fma_f32 v18, v18, v65, -v67
    v_mul_u32_u24 v64, 2, v7
    v_cvt_f32_u32 v64, v64
    v_mul_f32 v64, 0x3b000000, v64
    v_cos_f32 v65, v64
    v_sin_f32 v66, v64
    s_nop 0
    v_mul_f32 v67, v21, v66
    v_mul_f32 v68, v21, v65
    v_fma_f32 v21, v20, v66, v68
    v_fma_f32 v20, v20, v65, -v67
    v_mul_u32_u24 v64, 3, v7
    v_cvt_f32_u32 v64, v64
    v_mul_f32 v64, 0x3b000000, v64
    v_cos_f32 v65, v64
    v_sin_f32 v66, v64
    s_nop 0
    v_mul_f32 v67, v23, v66
    v_mul_f32 v68, v23, v65
    v_fma_f32 v23, v22, v66, v68
    v_fma_f32 v22, v22, v65, -v67
    v_mul_u32_u24 v64, 4, v7
    v_cvt_f32_u32 v64, v64
    v_mul_f32 v64, 0x3b000000, v64
    v_cos_f32 v65, v64
    v_sin_f32 v66, v64
    s_nop 0
    v_mul_f32 v67, v25, v66
    v_mul_f32 v68, v25, v65
    v_fma_f32 v25, v24, v66, v68
    v_fma_f32 v24, v24, v65, -v67
    v_mul_u32_u24 v64, 5, v7
    v_cvt_f32_u32 v64, v64
    v_mul_f32 v64, 0x3b000000, v64
    v_cos_f32 v65, v64
    v_sin_f32 v66, v64
    s_nop 0
    v_mul_f32 v67, v27, v66
    v_mul_f32 v68, v27, v65
    v_fma_f32 v27, v26, v66, v68
    v_fma_f32 v26, v26, v65, -v67
    v_mul_u32_u24 v64, 6, v7
    v_cvt_f32_u32 v64, v64
    v_mul_f32 v64, 0x3b000000, v64
    v_cos_f32 v65, v64
    v_sin_f32 v66, v64
    s_nop 0
    v_mul_f32 v67, v29, v66
    v_mul_f32 v68, v29, v65
    v_fma_f32 v29, v28, v66, v68
    v_fma_f32 v28, v28, v65, -v67
    v_mul_u32_u24 v64, 7, v7
    v_cvt_f32_u32 v64, v64
    v_mul_f32 v64, 0x3b000000, v64
    v_cos_f32 v65, v64
    v_sin_f32 v66, v64
    s_nop 0
    v_mul_f32 v67, v31, v66
    v_mul_f32 v68, v31, v65
    v_fma_f32 v31, v30, v66, v68
    v_fma_f32 v30, v30, v65, -v67
    v_add_f32 v32, v16, v24
    v_add_f32 v33, v17, v25
    v_sub_f32 v34, v16, v24
    v_sub_f32 v35, v17, v25
    v_add_f32 v36, v20, v28
    v_add_f32 v37, v21, v29
    v_sub_f32 v38, v20, v28
    v_sub_f32 v39, v21, v29
    v_add_f32 v40, v18, v26
    v_add_f32 v41, v19, v27
    v_sub_f32 v42, v18, v26
    v_sub_f32 v43, v19, v27
    v_add_f32 v44, v22, v30
    v_add_f32 v45, v23, v31
    v_sub_f32 v46, v22, v30
    v_sub_f32 v47, v23, v31
    v_add_f32 v48, v32, v36
    v_add_f32 v49, v33, v37
    v_sub_f32 v52, v32, v36
    v_sub_f32 v53, v33, v37
    v_sub_f32 v16, 0, v39
    v_mov_b32 v17, v38
    v_add_f32 v50, v34, v16
    v_add_f32 v51, v35, v17
    v_sub_f32 v54, v34, v16
    v_sub_f32 v55, v35, v17
    v_add_f32 v56, v40, v44
    v_add_f32 v57, v41, v45
    v_sub_f32 v60, v40, v44
    v_sub_f32 v61, v41, v45
    v_sub_f32 v16, 0, v47
    v_mov_b32 v17, v46
    v_add_f32 v58, v42, v16
    v_add_f32 v59, v43, v17
    v_sub_f32 v62, v42, v16
    v_sub_f32 v63, v43, v17
    v_sub_f32 v18, v58, v59
    v_add_f32 v19, v59, v58
    v_mul_f32 v58, 0x3f3504f3, v18
    v_mul_f32 v59, 0x3f3504f3, v19
    v_add_f32 v18, v62, v63
    v_sub_f32 v19, v63, v62
    v_mul_f32 v62, 0xbf3504f3, v18
    v_mul_f32 v63, 0xbf3504f3, v19
    v_sub_f32 v20, 0, v61
    v_mov_b32 v21, v60
    v_mov_b32 v60, v20
    v_mov_b32 v61, v21
    v_add_f32 v16, v48, v56
    v_add_f32 v17, v49, v57
    v_sub_f32 v24, v48, v56
    v_sub_f32 v25, v49, v57
    v_add_f32 v18, v50, v58
    v_add_f32 v19, v51, v59
    v_sub_f32 v26, v50, v58
    v_sub_f32 v27, v51, v59
    v_add_f32 v20, v52, v60
    v_add_f32 v21, v53, v61
    v_sub_f32 v28, v52, v60
    v_sub_f32 v29, v53, v61
    v_add_f32 v22, v54, v62
    v_add_f32 v23, v55, v63
    v_sub_f32 v30, v54, v62
    v_sub_f32 v31, v55, v63
    v_lshlrev_b32 v9, 11, v8
    v_lshlrev_b32 v10, 1, v7
    v_add_u32 v9, v9, v10
    buffer_load_ushort v32, v9, s[4:7], 0 offen offset:0
    buffer_load_ushort v33, v9, s[4:7], 0 offen offset:1024
    buffer_load_ushort v34, v9, s[4:7], 0 offen offset:128
    buffer_load_ushort v35, v9, s[4:7], 0 offen offset:1152
    buffer_load_ushort v36, v9, s[4:7], 0 offen offset:256
    buffer_load_ushort v37, v9, s[4:7], 0 offen offset:1280
    buffer_load_ushort v38, v9, s[4:7], 0 offen offset:384
    buffer_load_ushort v39, v9, s[4:7], 0 offen offset:1408
    buffer_load_ushort v40, v9, s[4:7], 0 offen offset:512
    buffer_load_ushort v41, v9, s[4:7], 0 offen offset:1536
    buffer_load_ushort v42, v9, s[4:7], 0 offen offset:640
    buffer_load_ushort v43, v9, s[4:7], 0 offen offset:1664
    buffer_load_ushort v44, v9, s[4:7], 0 offen offset:768
    buffer_load_ushort v45, v9, s[4:7], 0 offen offset:1792
    buffer_load_ushort v46, v9, s[4:7], 0 offen offset:896
    buffer_load_ushort v47, v9, s[4:7], 0 offen offset:1920
    s_waitcnt vmcnt(0)
    v_cvt_pk_bf16_f32 v16, v16, v16
    v_lshlrev_b32 v16, 16, v16
    v_lshlrev_b32 v32, 16, v32
    v_add_f32 v16, v16, v32
    v_cvt_pk_bf16_f32 v16, v16, v16
    buffer_store_short v16, v9, s[12:15], 0 offen offset:0
    v_lshlrev_b32 v32, 16, v16
    v_cvt_pk_bf16_f32 v17, v17, v17
    v_lshlrev_b32 v17, 16, v17
    v_lshlrev_b32 v33, 16, v33
    v_add_f32 v17, v17, v33
    v_cvt_pk_bf16_f32 v17, v17, v17
    buffer_store_short v17, v9, s[12:15], 0 offen offset:1024
    v_lshlrev_b32 v33, 16, v17
    v_cvt_pk_bf16_f32 v18, v18, v18
    v_lshlrev_b32 v18, 16, v18
    v_lshlrev_b32 v34, 16, v34
    v_add_f32 v18, v18, v34
    v_cvt_pk_bf16_f32 v18, v18, v18
    buffer_store_short v18, v9, s[12:15], 0 offen offset:128
    v_lshlrev_b32 v34, 16, v18
    v_cvt_pk_bf16_f32 v19, v19, v19
    v_lshlrev_b32 v19, 16, v19
    v_lshlrev_b32 v35, 16, v35
    v_add_f32 v19, v19, v35
    v_cvt_pk_bf16_f32 v19, v19, v19
    buffer_store_short v19, v9, s[12:15], 0 offen offset:1152
    v_lshlrev_b32 v35, 16, v19
    v_cvt_pk_bf16_f32 v20, v20, v20
    v_lshlrev_b32 v20, 16, v20
    v_lshlrev_b32 v36, 16, v36
    v_add_f32 v20, v20, v36
    v_cvt_pk_bf16_f32 v20, v20, v20
    buffer_store_short v20, v9, s[12:15], 0 offen offset:256
    v_lshlrev_b32 v36, 16, v20
    v_cvt_pk_bf16_f32 v21, v21, v21
    v_lshlrev_b32 v21, 16, v21
    v_lshlrev_b32 v37, 16, v37
    v_add_f32 v21, v21, v37
    v_cvt_pk_bf16_f32 v21, v21, v21
    buffer_store_short v21, v9, s[12:15], 0 offen offset:1280
    v_lshlrev_b32 v37, 16, v21
    v_cvt_pk_bf16_f32 v22, v22, v22
    v_lshlrev_b32 v22, 16, v22
    v_lshlrev_b32 v38, 16, v38
    v_add_f32 v22, v22, v38
    v_cvt_pk_bf16_f32 v22, v22, v22
    buffer_store_short v22, v9, s[12:15], 0 offen offset:384
    v_lshlrev_b32 v38, 16, v22
    v_cvt_pk_bf16_f32 v23, v23, v23
    v_lshlrev_b32 v23, 16, v23
    v_lshlrev_b32 v39, 16, v39
    v_add_f32 v23, v23, v39
    v_cvt_pk_bf16_f32 v23, v23, v23
    buffer_store_short v23, v9, s[12:15], 0 offen offset:1408
    v_lshlrev_b32 v39, 16, v23
    v_cvt_pk_bf16_f32 v24, v24, v24
    v_lshlrev_b32 v24, 16, v24
    v_lshlrev_b32 v40, 16, v40
    v_add_f32 v24, v24, v40
    v_cvt_pk_bf16_f32 v24, v24, v24
    buffer_store_short v24, v9, s[12:15], 0 offen offset:512
    v_lshlrev_b32 v40, 16, v24
    v_cvt_pk_bf16_f32 v25, v25, v25
    v_lshlrev_b32 v25, 16, v25
    v_lshlrev_b32 v41, 16, v41
    v_add_f32 v25, v25, v41
    v_cvt_pk_bf16_f32 v25, v25, v25
    buffer_store_short v25, v9, s[12:15], 0 offen offset:1536
    v_lshlrev_b32 v41, 16, v25
    v_cvt_pk_bf16_f32 v26, v26, v26
    v_lshlrev_b32 v26, 16, v26
    v_lshlrev_b32 v42, 16, v42
    v_add_f32 v26, v26, v42
    v_cvt_pk_bf16_f32 v26, v26, v26
    buffer_store_short v26, v9, s[12:15], 0 offen offset:640
    v_lshlrev_b32 v42, 16, v26
    v_cvt_pk_bf16_f32 v27, v27, v27
    v_lshlrev_b32 v27, 16, v27
    v_lshlrev_b32 v43, 16, v43
    v_add_f32 v27, v27, v43
    v_cvt_pk_bf16_f32 v27, v27, v27
    buffer_store_short v27, v9, s[12:15], 0 offen offset:1664
    v_lshlrev_b32 v43, 16, v27
    v_cvt_pk_bf16_f32 v28, v28, v28
    v_lshlrev_b32 v28, 16, v28
    v_lshlrev_b32 v44, 16, v44
    v_add_f32 v28, v28, v44
    v_cvt_pk_bf16_f32 v28, v28, v28
    buffer_store_short v28, v9, s[12:15], 0 offen offset:768
    v_lshlrev_b32 v44, 16, v28
    v_cvt_pk_bf16_f32 v29, v29, v29
    v_lshlrev_b32 v29, 16, v29
    v_lshlrev_b32 v45, 16, v45
    v_add_f32 v29, v29, v45
    v_cvt_pk_bf16_f32 v29, v29, v29
    buffer_store_short v29, v9, s[12:15], 0 offen offset:1792
    v_lshlrev_b32 v45, 16, v29
    v_cvt_pk_bf16_f32 v30, v30, v30
    v_lshlrev_b32 v30, 16, v30
    v_lshlrev_b32 v46, 16, v46
    v_add_f32 v30, v30, v46
    v_cvt_pk_bf16_f32 v30, v30, v30
    buffer_store_short v30, v9, s[12:15], 0 offen offset:896
    v_lshlrev_b32 v46, 16, v30
    v_cvt_pk_bf16_f32 v31, v31, v31
    v_lshlrev_b32 v31, 16, v31
    v_lshlrev_b32 v47, 16, v47
    v_add_f32 v31, v31, v47
    v_cvt_pk_bf16_f32 v31, v31, v31
    buffer_store_short v31, v9, s[12:15], 0 offen offset:1920
    v_lshlrev_b32 v47, 16, v31
    v_add_f32 v76, v32, v34
    v_add_f32 v76, v76, v36
    v_add_f32 v76, v76, v38
    v_add_f32 v76, v76, v40
    v_add_f32 v76, v76, v42
    v_add_f32 v76, v76, v44
    v_add_f32 v76, v76, v46
    v_add_f32 v77, v33, v35
    v_add_f32 v77, v77, v37
    v_add_f32 v77, v77, v39
    v_add_f32 v77, v77, v41
    v_add_f32 v77, v77, v43
    v_add_f32 v77, v77, v45
    v_add_f32 v77, v77, v47
    v_xor_b32 v70, 32, v1
    v_lshlrev_b32 v70, 2, v70
    ds_bpermute_b32 v71, v70, v76
    ds_bpermute_b32 v72, v70, v77
    s_waitcnt lgkmcnt(0)
    v_add_f32 v76, v76, v71
    v_add_f32 v77, v77, v72
    v_xor_b32 v70, 16, v1
    v_lshlrev_b32 v70, 2, v70
    ds_bpermute_b32 v71, v70, v76
    ds_bpermute_b32 v72, v70, v77
    s_waitcnt lgkmcnt(0)
    v_add_f32 v76, v76, v71
    v_add_f32 v77, v77, v72
    v_xor_b32 v70, 8, v1
    v_lshlrev_b32 v70, 2, v70
    ds_bpermute_b32 v71, v70, v76
    ds_bpermute_b32 v72, v70, v77
    s_waitcnt lgkmcnt(0)
    v_add_f32 v76, v76, v71
    v_add_f32 v77, v77, v72
    v_xor_b32 v70, 4, v1
    v_lshlrev_b32 v70, 2, v70
    ds_bpermute_b32 v71, v70, v76
    ds_bpermute_b32 v72, v70, v77
    s_waitcnt lgkmcnt(0)
    v_add_f32 v76, v76, v71
    v_add_f32 v77, v77, v72
    v_xor_b32 v70, 2, v1
    v_lshlrev_b32 v70, 2, v70
    ds_bpermute_b32 v71, v70, v76
    ds_bpermute_b32 v72, v70, v77
    s_waitcnt lgkmcnt(0)
    v_add_f32 v76, v76, v71
    v_add_f32 v77, v77, v72
    v_xor_b32 v70, 1, v1
    v_lshlrev_b32 v70, 2, v70
    ds_bpermute_b32 v71, v70, v76
    ds_bpermute_b32 v72, v70, v77
    s_waitcnt lgkmcnt(0)
    v_add_f32 v76, v76, v71
    v_add_f32 v77, v77, v72
    v_mul_f32 v76, 0x3b000000, v76
    v_mul_f32 v77, 0x3b000000, v77
    v_mov_b32 v78, 0
    v_sub_f32 v70, v32, v76
    v_fmac_f32 v78, v70, v70
    v_sub_f32 v70, v34, v76
    v_fmac_f32 v78, v70, v70
    v_sub_f32 v70, v36, v76
    v_fmac_f32 v78, v70, v70
    v_sub_f32 v70, v38, v76
    v_fmac_f32 v78, v70, v70
    v_sub_f32 v70, v40, v76
    v_fmac_f32 v78, v70, v70
    v_sub_f32 v70, v42, v76
    v_fmac_f32 v78, v70, v70
    v_sub_f32 v70, v44, v76
    v_fmac_f32 v78, v70, v70
    v_sub_f32 v70, v46, v76
    v_fmac_f32 v78, v70, v70
    v_mov_b32 v79, 0
    v_sub_f32 v70, v33, v77
    v_fmac_f32 v79, v70, v70
    v_sub_f32 v70, v35, v77
    v_fmac_f32 v79, v70, v70
    v_sub_f32 v70, v37, v77
    v_fmac_f32 v79, v70, v70
    v_sub_f32 v70, v39, v77
    v_fmac_f32 v79, v70, v70
    v_sub_f32 v70, v41, v77
    v_fmac_f32 v79, v70, v70
    v_sub_f32 v70, v43, v77
    v_fmac_f32 v79, v70, v70
    v_sub_f32 v70, v45, v77
    v_fmac_f32 v79, v70, v70
    v_sub_f32 v70, v47, v77
    v_fmac_f32 v79, v70, v70
    v_xor_b32 v70, 32, v1
    v_lshlrev_b32 v70, 2, v70
    ds_bpermute_b32 v71, v70, v78
    ds_bpermute_b32 v72, v70, v79
    s_waitcnt lgkmcnt(0)
    v_add_f32 v78, v78, v71
    v_add_f32 v79, v79, v72
    v_xor_b32 v70, 16, v1
    v_lshlrev_b32 v70, 2, v70
    ds_bpermute_b32 v71, v70, v78
    ds_bpermute_b32 v72, v70, v79
    s_waitcnt lgkmcnt(0)
    v_add_f32 v78, v78, v71
    v_add_f32 v79, v79, v72
    v_xor_b32 v70, 8, v1
    v_lshlrev_b32 v70, 2, v70
    ds_bpermute_b32 v71, v70, v78
    ds_bpermute_b32 v72, v70, v79
    s_waitcnt lgkmcnt(0)
    v_add_f32 v78, v78, v71
    v_add_f32 v79, v79, v72
    v_xor_b32 v70, 4, v1
    v_lshlrev_b32 v70, 2, v70
    ds_bpermute_b32 v71, v70, v78
    ds_bpermute_b32 v72, v70, v79
    s_waitcnt lgkmcnt(0)
    v_add_f32 v78, v78, v71
    v_add_f32 v79, v79, v72
    v_xor_b32 v70, 2, v1
    v_lshlrev_b32 v70, 2, v70
    ds_bpermute_b32 v71, v70, v78
    ds_bpermute_b32 v72, v70, v79
    s_waitcnt lgkmcnt(0)
    v_add_f32 v78, v78, v71
    v_add_f32 v79, v79, v72
    v_xor_b32 v70, 1, v1
    v_lshlrev_b32 v70, 2, v70
    ds_bpermute_b32 v71, v70, v78
    ds_bpermute_b32 v72, v70, v79
    s_waitcnt lgkmcnt(0)
    v_add_f32 v78, v78, v71
    v_add_f32 v79, v79, v72
    v_mul_f32 v78, 0x3b000000, v78
    v_cvt_pk_bf16_f32 v78, v78, v78
    v_lshlrev_b32 v78, 16, v78
    v_add_f32 v78, 0x3727c5ac, v78
    v_cvt_pk_bf16_f32 v78, v78, v78
    v_lshlrev_b32 v78, 16, v78
    v_sqrt_f32 v78, v78
    s_nop 0
    v_cvt_pk_bf16_f32 v78, v78, v78
    v_lshlrev_b32 v78, 16, v78
    v_rcp_f32 v78, v78
    v_cvt_pk_bf16_f32 v76, v76, v76
    v_lshlrev_b32 v76, 16, v76
    v_sub_f32 v32, v32, v76
    v_cvt_pk_bf16_f32 v32, v32, v32
    v_lshlrev_b32 v32, 16, v32
    v_mul_f32 v32, v32, v78
    v_cvt_pk_bf16_f32 v32, v32, v32
    v_lshlrev_b32 v32, 16, v32
    v_sub_f32 v34, v34, v76
    v_cvt_pk_bf16_f32 v34, v34, v34
    v_lshlrev_b32 v34, 16, v34
    v_mul_f32 v34, v34, v78
    v_cvt_pk_bf16_f32 v34, v34, v34
    v_lshlrev_b32 v34, 16, v34
    v_sub_f32 v36, v36, v76
    v_cvt_pk_bf16_f32 v36, v36, v36
    v_lshlrev_b32 v36, 16, v36
    v_mul_f32 v36, v36, v78
    v_cvt_pk_bf16_f32 v36, v36, v36
    v_lshlrev_b32 v36, 16, v36
    v_sub_f32 v38, v38, v76
    v_cvt_pk_bf16_f32 v38, v38, v38
    v_lshlrev_b32 v38, 16, v38
    v_mul_f32 v38, v38, v78
    v_cvt_pk_bf16_f32 v38, v38, v38
    v_lshlrev_b32 v38, 16, v38
    v_sub_f32 v40, v40, v76
    v_cvt_pk_bf16_f32 v40, v40, v40
    v_lshlrev_b32 v40, 16, v40
    v_mul_f32 v40, v40, v78
    v_cvt_pk_bf16_f32 v40, v40, v40
    v_lshlrev_b32 v40, 16, v40
    v_sub_f32 v42, v42, v76
    v_cvt_pk_bf16_f32 v42, v42, v42
    v_lshlrev_b32 v42, 16, v42
    v_mul_f32 v42, v42, v78
    v_cvt_pk_bf16_f32 v42, v42, v42
    v_lshlrev_b32 v42, 16, v42
    v_sub_f32 v44, v44, v76
    v_cvt_pk_bf16_f32 v44, v44, v44
    v_lshlrev_b32 v44, 16, v44
    v_mul_f32 v44, v44, v78
    v_cvt_pk_bf16_f32 v44, v44, v44
    v_lshlrev_b32 v44, 16, v44
    v_sub_f32 v46, v46, v76
    v_cvt_pk_bf16_f32 v46, v46, v46
    v_lshlrev_b32 v46, 16, v46
    v_mul_f32 v46, v46, v78
    v_cvt_pk_bf16_f32 v46, v46, v46
    v_lshlrev_b32 v46, 16, v46
    v_mul_f32 v79, 0x3b000000, v79
    v_cvt_pk_bf16_f32 v79, v79, v79
    v_lshlrev_b32 v79, 16, v79
    v_add_f32 v79, 0x3727c5ac, v79
    v_cvt_pk_bf16_f32 v79, v79, v79
    v_lshlrev_b32 v79, 16, v79
    v_sqrt_f32 v79, v79
    s_nop 0
    v_cvt_pk_bf16_f32 v79, v79, v79
    v_lshlrev_b32 v79, 16, v79
    v_rcp_f32 v79, v79
    v_cvt_pk_bf16_f32 v77, v77, v77
    v_lshlrev_b32 v77, 16, v77
    v_sub_f32 v33, v33, v77
    v_cvt_pk_bf16_f32 v33, v33, v33
    v_lshlrev_b32 v33, 16, v33
    v_mul_f32 v33, v33, v79
    v_cvt_pk_bf16_f32 v33, v33, v33
    v_lshlrev_b32 v33, 16, v33
    v_sub_f32 v35, v35, v77
    v_cvt_pk_bf16_f32 v35, v35, v35
    v_lshlrev_b32 v35, 16, v35
    v_mul_f32 v35, v35, v79
    v_cvt_pk_bf16_f32 v35, v35, v35
    v_lshlrev_b32 v35, 16, v35
    v_sub_f32 v37, v37, v77
    v_cvt_pk_bf16_f32 v37, v37, v37
    v_lshlrev_b32 v37, 16, v37
    v_mul_f32 v37, v37, v79
    v_cvt_pk_bf16_f32 v37, v37, v37
    v_lshlrev_b32 v37, 16, v37
    v_sub_f32 v39, v39, v77
    v_cvt_pk_bf16_f32 v39, v39, v39
    v_lshlrev_b32 v39, 16, v39
    v_mul_f32 v39, v39, v79
    v_cvt_pk_bf16_f32 v39, v39, v39
    v_lshlrev_b32 v39, 16, v39
    v_sub_f32 v41, v41, v77
    v_cvt_pk_bf16_f32 v41, v41, v41
    v_lshlrev_b32 v41, 16, v41
    v_mul_f32 v41, v41, v79
    v_cvt_pk_bf16_f32 v41, v41, v41
    v_lshlrev_b32 v41, 16, v41
    v_sub_f32 v43, v43, v77
    v_cvt_pk_bf16_f32 v43, v43, v43
    v_lshlrev_b32 v43, 16, v43
    v_mul_f32 v43, v43, v79
    v_cvt_pk_bf16_f32 v43, v43, v43
    v_lshlrev_b32 v43, 16, v43
    v_sub_f32 v45, v45, v77
    v_cvt_pk_bf16_f32 v45, v45, v45
    v_lshlrev_b32 v45, 16, v45
    v_mul_f32 v45, v45, v79
    v_cvt_pk_bf16_f32 v45, v45, v45
    v_lshlrev_b32 v45, 16, v45
    v_sub_f32 v47, v47, v77
    v_cvt_pk_bf16_f32 v47, v47, v47
    v_lshlrev_b32 v47, 16, v47
    v_mul_f32 v47, v47, v79
    v_cvt_pk_bf16_f32 v47, v47, v47
    v_lshlrev_b32 v47, 16, v47
    v_lshrrev_b32 v32, 16, v32
    buffer_store_short v32, v9, s[40:43], 0 offen offset:0
    v_lshrrev_b32 v33, 16, v33
    buffer_store_short v33, v9, s[40:43], 0 offen offset:1024
    v_lshrrev_b32 v34, 16, v34
    buffer_store_short v34, v9, s[40:43], 0 offen offset:128
    v_lshrrev_b32 v35, 16, v35
    buffer_store_short v35, v9, s[40:43], 0 offen offset:1152
    v_lshrrev_b32 v36, 16, v36
    buffer_store_short v36, v9, s[40:43], 0 offen offset:256
    v_lshrrev_b32 v37, 16, v37
    buffer_store_short v37, v9, s[40:43], 0 offen offset:1280
    v_lshrrev_b32 v38, 16, v38
    buffer_store_short v38, v9, s[40:43], 0 offen offset:384
    v_lshrrev_b32 v39, 16, v39
    buffer_store_short v39, v9, s[40:43], 0 offen offset:1408
    v_lshrrev_b32 v40, 16, v40
    buffer_store_short v40, v9, s[40:43], 0 offen offset:512
    v_lshrrev_b32 v41, 16, v41
    buffer_store_short v41, v9, s[40:43], 0 offen offset:1536
    v_lshrrev_b32 v42, 16, v42
    buffer_store_short v42, v9, s[40:43], 0 offen offset:640
    v_lshrrev_b32 v43, 16, v43
    buffer_store_short v43, v9, s[40:43], 0 offen offset:1664
    v_lshrrev_b32 v44, 16, v44
    buffer_store_short v44, v9, s[40:43], 0 offen offset:768
    v_lshrrev_b32 v45, 16, v45
    buffer_store_short v45, v9, s[40:43], 0 offen offset:1792
    v_lshrrev_b32 v46, 16, v46
    buffer_store_short v46, v9, s[40:43], 0 offen offset:896
    v_lshrrev_b32 v47, 16, v47
    buffer_store_short v47, v9, s[40:43], 0 offen offset:1920
K3_END:
    s_endpgm
.globl k4_kernel
.p2align 8
.type k4_kernel,@function
k4_kernel:
    s_load_dwordx16 s[16:31], s[0:1], 0
    s_load_dwordx4 s[32:35], s[0:1], 64
    s_waitcnt lgkmcnt(0)
    s_and_b32 s3, s2, 15
    s_lshr_b32 s36, s2, 4
    s_cmp_ge_u32 s36, 22
    s_cbranch_scc1 K4_END
    s_add_u32 s4, s34, 0x700000
    s_addc_u32 s5, s35, 0
    s_and_b32 s5, s5, 0xffff
    s_mov_b32 s6, 0x200000
    s_mov_b32 s7, 0x20000
    s_add_u32 s8, s34, 0x1000000
    s_addc_u32 s9, s35, 0
    s_and_b32 s9, s9, 0xffff
    s_mov_b32 s10, 0x158000
    s_mov_b32 s11, 0x20000
    s_add_u32 s12, s34, 0x1200000
    s_addc_u32 s13, s35, 0
    s_and_b32 s13, s13, 0xffff
    s_mov_b32 s14, 0x158000
    s_mov_b32 s15, 0x20000
    s_add_u32 s40, s34, 0x900000
    s_addc_u32 s41, s35, 0
    s_and_b32 s41, s41, 0xffff
    s_mov_b32 s42, 0x560000
    s_mov_b32 s43, 0x20000
    s_lshl_b32 s3, s3, 7
    s_lshl_b32 s36, s36, 6
    v_and_b32 v1, 63, v0
    v_lshrrev_b32 v2, 6, v0
    v_and_b32 v3, 1, v2
    v_lshrrev_b32 v4, 1, v2
    v_lshlrev_b32 v3, 6, v3
    v_add_u32 v3, s3, v3
    v_lshlrev_b32 v4, 5, v4
    v_add_u32 v4, s36, v4
    v_and_b32 v5, 31, v1
    v_lshrrev_b32 v6, 5, v1
    v_lshlrev_b32 v6, 4, v6
    v_add_u32 v7, v3, v5
    v_mul_u32_u24 v7, 1024, v7
    v_add_u32 v7, v7, v6
    v_add_u32 v8, 32768, v7
    v_add_u32 v9, v4, v5
    v_mul_u32_u24 v9, 1024, v9
    v_add_u32 v9, v9, v6
    v_mov_b32 v64, 0
    v_mov_b32 v65, 0
    v_mov_b32 v66, 0
    v_mov_b32 v67, 0
    v_mov_b32 v68, 0
    v_mov_b32 v69, 0
    v_mov_b32 v70, 0
    v_mov_b32 v71, 0
    v_mov_b32 v72, 0
    v_mov_b32 v73, 0
    v_mov_b32 v74, 0
    v_mov_b32 v75, 0
    v_mov_b32 v76, 0
    v_mov_b32 v77, 0
    v_mov_b32 v78, 0
    v_mov_b32 v79, 0
    v_mov_b32 v80, 0
    v_mov_b32 v81, 0
    v_mov_b32 v82, 0
    v_mov_b32 v83, 0
    v_mov_b32 v84, 0
    v_mov_b32 v85, 0
    v_mov_b32 v86, 0
    v_mov_b32 v87, 0
    v_mov_b32 v88, 0
    v_mov_b32 v89, 0
    v_mov_b32 v90, 0
    v_mov_b32 v91, 0
    v_mov_b32 v92, 0
    v_mov_b32 v93, 0
    v_mov_b32 v94, 0
    v_mov_b32 v95, 0
    v_mov_b32 v96, 0
    v_mov_b32 v97, 0
    v_mov_b32 v98, 0
    v_mov_b32 v99, 0
    v_mov_b32 v100, 0
    v_mov_b32 v101, 0
    v_mov_b32 v102, 0
    v_mov_b32 v103, 0
    v_mov_b32 v104, 0
    v_mov_b32 v105, 0
    v_mov_b32 v106, 0
    v_mov_b32 v107, 0
    v_mov_b32 v108, 0
    v_mov_b32 v109, 0
    v_mov_b32 v110, 0
    v_mov_b32 v111, 0
    v_mov_b32 v112, 0
    v_mov_b32 v113, 0
    v_mov_b32 v114, 0
    v_mov_b32 v115, 0
    v_mov_b32 v116, 0
    v_mov_b32 v117, 0
    v_mov_b32 v118, 0
    v_mov_b32 v119, 0
    v_mov_b32 v120, 0
    v_mov_b32 v121, 0
    v_mov_b32 v122, 0
    v_mov_b32 v123, 0
    v_mov_b32 v124, 0
    v_mov_b32 v125, 0
    v_mov_b32 v126, 0
    v_mov_b32 v127, 0
    v_lshrrev_b32 v10, 3, v0
    v_and_b32 v11, 7, v0
    v_lshlrev_b32 v11, 4, v11
    v_mul_u32_u24 v12, 144, v10
    v_add_u32 v12, v12, v11
    v_add_u32 v13, s3, v10
    v_mul_u32_u24 v13, 1024, v13
    v_add_u32 v13, v13, v11
    v_add_u32 v14, s36, v10
    v_mul_u32_u24 v14, 1024, v14
    v_add_u32 v14, v14, v11
    v_sub_u32 v7, v3, s3
    v_add_u32 v7, v7, v5
    v_mul_u32_u24 v7, 144, v7
    v_add_u32 v7, v7, v6
    v_sub_u32 v9, v4, s36
    v_add_u32 v9, v9, v5
    v_mul_u32_u24 v9, 144, v9
    v_add_u32 v9, v9, v6
    v_add_u32 v9, 18432, v9
    v_add_u32 v15, 36864, v12
    v_add_u32 v8, 36864, v7
    v_add_u32 v10, 36864, v9
    s_mov_b32 s37, 0
    s_add_u32 s38, s37, 0
    buffer_load_dwordx4 v[16:19], v13, s[4:7], s38 offen
    s_add_u32 s38, s37, 32768
    buffer_load_dwordx4 v[20:23], v13, s[4:7], s38 offen
    s_add_u32 s38, s37, 65536
    buffer_load_dwordx4 v[24:27], v13, s[4:7], s38 offen
    s_add_u32 s38, s37, 98304
    buffer_load_dwordx4 v[28:31], v13, s[4:7], s38 offen
    s_add_u32 s38, s37, 0
    buffer_load_dwordx4 v[32:35], v14, s[8:11], s38 offen
    s_add_u32 s38, s37, 32768
    buffer_load_dwordx4 v[36:39], v14, s[8:11], s38 offen
    s_add_u32 s38, s37, 0
    buffer_load_dwordx4 v[40:43], v14, s[12:15], s38 offen
    s_add_u32 s38, s37, 32768
    buffer_load_dwordx4 v[44:47], v14, s[12:15], s38 offen
    s_add_u32 s37, s37, 128
    s_add_u32 s38, s37, 0
    buffer_load_dwordx4 v[128:131], v13, s[4:7], s38 offen
    s_add_u32 s38, s37, 32768
    buffer_load_dwordx4 v[132:135], v13, s[4:7], s38 offen
    s_add_u32 s38, s37, 65536
    buffer_load_dwordx4 v[136:139], v13, s[4:7], s38 offen
    s_add_u32 s38, s37, 98304
    buffer_load_dwordx4 v[140:143], v13, s[4:7], s38 offen
    s_add_u32 s38, s37, 0
    buffer_load_dwordx4 v[144:147], v14, s[8:11], s38 offen
    s_add_u32 s38, s37, 32768
    buffer_load_dwordx4 v[148:151], v14, s[8:11], s38 offen
    s_add_u32 s38, s37, 0
    buffer_load_dwordx4 v[152:155], v14, s[12:15], s38 offen
    s_add_u32 s38, s37, 32768
    buffer_load_dwordx4 v[156:159], v14, s[12:15], s38 offen
    s_waitcnt vmcnt(8)
    ds_write_b128 v12, v[16:19] offset:0
    ds_write_b128 v12, v[20:23] offset:4608
    ds_write_b128 v12, v[24:27] offset:9216
    ds_write_b128 v12, v[28:31] offset:13824
    ds_write_b128 v12, v[32:35] offset:18432
    ds_write_b128 v12, v[36:39] offset:23040
    ds_write_b128 v12, v[40:43] offset:27648
    ds_write_b128 v12, v[44:47] offset:32256
    s_waitcnt lgkmcnt(0)
    s_add_u32 s37, s37, 128
    s_add_u32 s38, s37, 0
    buffer_load_dwordx4 v[16:19], v13, s[4:7], s38 offen
    s_add_u32 s38, s37, 32768
    buffer_load_dwordx4 v[20:23], v13, s[4:7], s38 offen
    s_add_u32 s38, s37, 65536
    buffer_load_dwordx4 v[24:27], v13, s[4:7], s38 offen
    s_add_u32 s38, s37, 98304
    buffer_load_dwordx4 v[28:31], v13, s[4:7], s38 offen
    s_add_u32 s38, s37, 0
    buffer_load_dwordx4 v[32:35], v14, s[8:11], s38 offen
    s_add_u32 s38, s37, 32768
    buffer_load_dwordx4 v[36:39], v14, s[8:11], s38 offen
    s_add_u32 s38, s37, 0
    buffer_load_dwordx4 v[40:43], v14, s[12:15], s38 offen
    s_add_u32 s38, s37, 32768
    buffer_load_dwordx4 v[44:47], v14, s[12:15], s38 offen
    s_barrier
K4_L:
    ds_read_b128 v[48:51], v7 offset:0
    ds_read_b128 v[52:55], v7 offset:4608
    ds_read_b128 v[56:59], v9 offset:0
    ds_read_b128 v[60:63], v9 offset:9216
    ds_read_b128 v[160:163], v7 offset:32
    ds_read_b128 v[164:167], v7 offset:4640
    ds_read_b128 v[168:171], v9 offset:32
    ds_read_b128 v[172:175], v9 offset:9248
    s_waitcnt lgkmcnt(4)
    v_mfma_f32_32x32x16_bf16 v[64:79], v[48:51], v[56:59], v[64:79]
    v_mfma_f32_32x32x16_bf16 v[80:95], v[52:55], v[56:59], v[80:95]
    v_mfma_f32_32x32x16_bf16 v[96:111], v[48:51], v[60:63], v[96:111]
    v_mfma_f32_32x32x16_bf16 v[112:127], v[52:55], v[60:63], v[112:127]
    s_nop 1
    ds_read_b128 v[48:51], v7 offset:64
    ds_read_b128 v[52:55], v7 offset:4672
    ds_read_b128 v[56:59], v9 offset:64
    ds_read_b128 v[60:63], v9 offset:9280
    s_waitcnt lgkmcnt(4)
    v_mfma_f32_32x32x16_bf16 v[64:79], v[160:163], v[168:171], v[64:79]
    v_mfma_f32_32x32x16_bf16 v[80:95], v[164:167], v[168:171], v[80:95]
    v_mfma_f32_32x32x16_bf16 v[96:111], v[160:163], v[172:175], v[96:111]
    v_mfma_f32_32x32x16_bf16 v[112:127], v[164:167], v[172:175], v[112:127]
    s_nop 1
    ds_read_b128 v[160:163], v7 offset:96
    ds_read_b128 v[164:167], v7 offset:4704
    ds_read_b128 v[168:171], v9 offset:96
    ds_read_b128 v[172:175], v9 offset:9312
    s_waitcnt lgkmcnt(4)
    v_mfma_f32_32x32x16_bf16 v[64:79], v[48:51], v[56:59], v[64:79]
    v_mfma_f32_32x32x16_bf16 v[80:95], v[52:55], v[56:59], v[80:95]
    v_mfma_f32_32x32x16_bf16 v[96:111], v[48:51], v[60:63], v[96:111]
    v_mfma_f32_32x32x16_bf16 v[112:127], v[52:55], v[60:63], v[112:127]
    s_nop 1
    s_waitcnt lgkmcnt(0)
    v_mfma_f32_32x32x16_bf16 v[64:79], v[160:163], v[168:171], v[64:79]
    v_mfma_f32_32x32x16_bf16 v[80:95], v[164:167], v[168:171], v[80:95]
    v_mfma_f32_32x32x16_bf16 v[96:111], v[160:163], v[172:175], v[96:111]
    v_mfma_f32_32x32x16_bf16 v[112:127], v[164:167], v[172:175], v[112:127]
    s_nop 1
    s_waitcnt vmcnt(8)
    ds_write_b128 v15, v[128:131] offset:0
    ds_write_b128 v15, v[132:135] offset:4608
    ds_write_b128 v15, v[136:139] offset:9216
    ds_write_b128 v15, v[140:143] offset:13824
    ds_write_b128 v15, v[144:147] offset:18432
    ds_write_b128 v15, v[148:151] offset:23040
    ds_write_b128 v15, v[152:155] offset:27648
    ds_write_b128 v15, v[156:159] offset:32256
    s_waitcnt lgkmcnt(0)
    s_add_u32 s37, s37, 128
    s_add_u32 s38, s37, 0
    buffer_load_dwordx4 v[128:131], v13, s[4:7], s38 offen
    s_add_u32 s38, s37, 32768
    buffer_load_dwordx4 v[132:135], v13, s[4:7], s38 offen
    s_add_u32 s38, s37, 65536
    buffer_load_dwordx4 v[136:139], v13, s[4:7], s38 offen
    s_add_u32 s38, s37, 98304
    buffer_load_dwordx4 v[140:143], v13, s[4:7], s38 offen
    s_add_u32 s38, s37, 0
    buffer_load_dwordx4 v[144:147], v14, s[8:11], s38 offen
    s_add_u32 s38, s37, 32768
    buffer_load_dwordx4 v[148:151], v14, s[8:11], s38 offen
    s_add_u32 s38, s37, 0
    buffer_load_dwordx4 v[152:155], v14, s[12:15], s38 offen
    s_add_u32 s38, s37, 32768
    buffer_load_dwordx4 v[156:159], v14, s[12:15], s38 offen
    s_barrier
    s_cmp_gt_u32 s37, 1279
    s_cbranch_scc1 K4_D
    ds_read_b128 v[48:51], v8 offset:0
    ds_read_b128 v[52:55], v8 offset:4608
    ds_read_b128 v[56:59], v10 offset:0
    ds_read_b128 v[60:63], v10 offset:9216
    ds_read_b128 v[160:163], v8 offset:32
    ds_read_b128 v[164:167], v8 offset:4640
    ds_read_b128 v[168:171], v10 offset:32
    ds_read_b128 v[172:175], v10 offset:9248
    s_waitcnt lgkmcnt(4)
    v_mfma_f32_32x32x16_bf16 v[64:79], v[48:51], v[56:59], v[64:79]
    v_mfma_f32_32x32x16_bf16 v[80:95], v[52:55], v[56:59], v[80:95]
    v_mfma_f32_32x32x16_bf16 v[96:111], v[48:51], v[60:63], v[96:111]
    v_mfma_f32_32x32x16_bf16 v[112:127], v[52:55], v[60:63], v[112:127]
    s_nop 1
    ds_read_b128 v[48:51], v8 offset:64
    ds_read_b128 v[52:55], v8 offset:4672
    ds_read_b128 v[56:59], v10 offset:64
    ds_read_b128 v[60:63], v10 offset:9280
    s_waitcnt lgkmcnt(4)
    v_mfma_f32_32x32x16_bf16 v[64:79], v[160:163], v[168:171], v[64:79]
    v_mfma_f32_32x32x16_bf16 v[80:95], v[164:167], v[168:171], v[80:95]
    v_mfma_f32_32x32x16_bf16 v[96:111], v[160:163], v[172:175], v[96:111]
    v_mfma_f32_32x32x16_bf16 v[112:127], v[164:167], v[172:175], v[112:127]
    s_nop 1
    ds_read_b128 v[160:163], v8 offset:96
    ds_read_b128 v[164:167], v8 offset:4704
    ds_read_b128 v[168:171], v10 offset:96
    ds_read_b128 v[172:175], v10 offset:9312
    s_waitcnt lgkmcnt(4)
    v_mfma_f32_32x32x16_bf16 v[64:79], v[48:51], v[56:59], v[64:79]
    v_mfma_f32_32x32x16_bf16 v[80:95], v[52:55], v[56:59], v[80:95]
    v_mfma_f32_32x32x16_bf16 v[96:111], v[48:51], v[60:63], v[96:111]
    v_mfma_f32_32x32x16_bf16 v[112:127], v[52:55], v[60:63], v[112:127]
    s_nop 1
    s_waitcnt lgkmcnt(0)
    v_mfma_f32_32x32x16_bf16 v[64:79], v[160:163], v[168:171], v[64:79]
    v_mfma_f32_32x32x16_bf16 v[80:95], v[164:167], v[168:171], v[80:95]
    v_mfma_f32_32x32x16_bf16 v[96:111], v[160:163], v[172:175], v[96:111]
    v_mfma_f32_32x32x16_bf16 v[112:127], v[164:167], v[172:175], v[112:127]
    s_nop 1
    s_waitcnt vmcnt(8)
    ds_write_b128 v12, v[16:19] offset:0
    ds_write_b128 v12, v[20:23] offset:4608
    ds_write_b128 v12, v[24:27] offset:9216
    ds_write_b128 v12, v[28:31] offset:13824
    ds_write_b128 v12, v[32:35] offset:18432
    ds_write_b128 v12, v[36:39] offset:23040
    ds_write_b128 v12, v[40:43] offset:27648
    ds_write_b128 v12, v[44:47] offset:32256
    s_waitcnt lgkmcnt(0)
    s_add_u32 s37, s37, 128
    s_add_u32 s38, s37, 0
    buffer_load_dwordx4 v[16:19], v13, s[4:7], s38 offen
    s_add_u32 s38, s37, 32768
    buffer_load_dwordx4 v[20:23], v13, s[4:7], s38 offen
    s_add_u32 s38, s37, 65536
    buffer_load_dwordx4 v[24:27], v13, s[4:7], s38 offen
    s_add_u32 s38, s37, 98304
    buffer_load_dwordx4 v[28:31], v13, s[4:7], s38 offen
    s_add_u32 s38, s37, 0
    buffer_load_dwordx4 v[32:35], v14, s[8:11], s38 offen
    s_add_u32 s38, s37, 32768
    buffer_load_dwordx4 v[36:39], v14, s[8:11], s38 offen
    s_add_u32 s38, s37, 0
    buffer_load_dwordx4 v[40:43], v14, s[12:15], s38 offen
    s_add_u32 s38, s37, 32768
    buffer_load_dwordx4 v[44:47], v14, s[12:15], s38 offen
    s_barrier
    s_cmp_gt_u32 s37, 1279
    s_cbranch_scc1 K4_D
    s_branch K4_L
K4_D:
    s_waitcnt vmcnt(0)
    s_nop 15
    s_nop 15
    v_add_u32 v10, v4, v5
    v_lshrrev_b32 v6, 5, v1
    v_lshlrev_b32 v6, 2, v6
    v_add_u32 v6, v6, v3
    v_cmp_gt_u32 vcc, 1376, v10
    s_and_saveexec_b64 s[38:39], vcc
    v_add_u32 v11, 0, v6
    v_mul_u32_u24 v11, 2752, v11
    v_lshlrev_b32 v12, 1, v10
    v_add_u32 v11, v11, v12
    v_cvt_pk_bf16_f32 v64, v64, v64
    v_lshlrev_b32 v64, 16, v64
    v_cvt_pk_bf16_f32 v96, v96, v96
    v_lshlrev_b32 v96, 16, v96
    v_mul_f32 v13, v64, v64
    v_mul_f32 v13, 0x3d372713, v13
    v_fma_f32 v13, v13, v64, v64
    v_mul_f32 v13, 0x40135761, v13
    v_exp_f32 v13, v13
    s_nop 0
    v_add_f32 v13, 1.0, v13
    v_rcp_f32 v13, v13
    s_nop 0
    v_fma_f32 v13, -v13, v64, v64
    v_cvt_pk_bf16_f32 v13, v13, v13
    v_lshlrev_b32 v13, 16, v13
    v_mul_f32 v64, v13, v96
    v_cvt_pk_bf16_f32 v64, v64, v64
    buffer_store_short v64, v11, s[40:43], 0 offen
    v_add_u32 v11, 1, v6
    v_mul_u32_u24 v11, 2752, v11
    v_lshlrev_b32 v12, 1, v10
    v_add_u32 v11, v11, v12
    v_cvt_pk_bf16_f32 v65, v65, v65
    v_lshlrev_b32 v65, 16, v65
    v_cvt_pk_bf16_f32 v97, v97, v97
    v_lshlrev_b32 v97, 16, v97
    v_mul_f32 v13, v65, v65
    v_mul_f32 v13, 0x3d372713, v13
    v_fma_f32 v13, v13, v65, v65
    v_mul_f32 v13, 0x40135761, v13
    v_exp_f32 v13, v13
    s_nop 0
    v_add_f32 v13, 1.0, v13
    v_rcp_f32 v13, v13
    s_nop 0
    v_fma_f32 v13, -v13, v65, v65
    v_cvt_pk_bf16_f32 v13, v13, v13
    v_lshlrev_b32 v13, 16, v13
    v_mul_f32 v65, v13, v97
    v_cvt_pk_bf16_f32 v65, v65, v65
    buffer_store_short v65, v11, s[40:43], 0 offen
    v_add_u32 v11, 2, v6
    v_mul_u32_u24 v11, 2752, v11
    v_lshlrev_b32 v12, 1, v10
    v_add_u32 v11, v11, v12
    v_cvt_pk_bf16_f32 v66, v66, v66
    v_lshlrev_b32 v66, 16, v66
    v_cvt_pk_bf16_f32 v98, v98, v98
    v_lshlrev_b32 v98, 16, v98
    v_mul_f32 v13, v66, v66
    v_mul_f32 v13, 0x3d372713, v13
    v_fma_f32 v13, v13, v66, v66
    v_mul_f32 v13, 0x40135761, v13
    v_exp_f32 v13, v13
    s_nop 0
    v_add_f32 v13, 1.0, v13
    v_rcp_f32 v13, v13
    s_nop 0
    v_fma_f32 v13, -v13, v66, v66
    v_cvt_pk_bf16_f32 v13, v13, v13
    v_lshlrev_b32 v13, 16, v13
    v_mul_f32 v66, v13, v98
    v_cvt_pk_bf16_f32 v66, v66, v66
    buffer_store_short v66, v11, s[40:43], 0 offen
    v_add_u32 v11, 3, v6
    v_mul_u32_u24 v11, 2752, v11
    v_lshlrev_b32 v12, 1, v10
    v_add_u32 v11, v11, v12
    v_cvt_pk_bf16_f32 v67, v67, v67
    v_lshlrev_b32 v67, 16, v67
    v_cvt_pk_bf16_f32 v99, v99, v99
    v_lshlrev_b32 v99, 16, v99
    v_mul_f32 v13, v67, v67
    v_mul_f32 v13, 0x3d372713, v13
    v_fma_f32 v13, v13, v67, v67
    v_mul_f32 v13, 0x40135761, v13
    v_exp_f32 v13, v13
    s_nop 0
    v_add_f32 v13, 1.0, v13
    v_rcp_f32 v13, v13
    s_nop 0
    v_fma_f32 v13, -v13, v67, v67
    v_cvt_pk_bf16_f32 v13, v13, v13
    v_lshlrev_b32 v13, 16, v13
    v_mul_f32 v67, v13, v99
    v_cvt_pk_bf16_f32 v67, v67, v67
    buffer_store_short v67, v11, s[40:43], 0 offen
    v_add_u32 v11, 8, v6
    v_mul_u32_u24 v11, 2752, v11
    v_lshlrev_b32 v12, 1, v10
    v_add_u32 v11, v11, v12
    v_cvt_pk_bf16_f32 v68, v68, v68
    v_lshlrev_b32 v68, 16, v68
    v_cvt_pk_bf16_f32 v100, v100, v100
    v_lshlrev_b32 v100, 16, v100
    v_mul_f32 v13, v68, v68
    v_mul_f32 v13, 0x3d372713, v13
    v_fma_f32 v13, v13, v68, v68
    v_mul_f32 v13, 0x40135761, v13
    v_exp_f32 v13, v13
    s_nop 0
    v_add_f32 v13, 1.0, v13
    v_rcp_f32 v13, v13
    s_nop 0
    v_fma_f32 v13, -v13, v68, v68
    v_cvt_pk_bf16_f32 v13, v13, v13
    v_lshlrev_b32 v13, 16, v13
    v_mul_f32 v68, v13, v100
    v_cvt_pk_bf16_f32 v68, v68, v68
    buffer_store_short v68, v11, s[40:43], 0 offen
    v_add_u32 v11, 9, v6
    v_mul_u32_u24 v11, 2752, v11
    v_lshlrev_b32 v12, 1, v10
    v_add_u32 v11, v11, v12
    v_cvt_pk_bf16_f32 v69, v69, v69
    v_lshlrev_b32 v69, 16, v69
    v_cvt_pk_bf16_f32 v101, v101, v101
    v_lshlrev_b32 v101, 16, v101
    v_mul_f32 v13, v69, v69
    v_mul_f32 v13, 0x3d372713, v13
    v_fma_f32 v13, v13, v69, v69
    v_mul_f32 v13, 0x40135761, v13
    v_exp_f32 v13, v13
    s_nop 0
    v_add_f32 v13, 1.0, v13
    v_rcp_f32 v13, v13
    s_nop 0
    v_fma_f32 v13, -v13, v69, v69
    v_cvt_pk_bf16_f32 v13, v13, v13
    v_lshlrev_b32 v13, 16, v13
    v_mul_f32 v69, v13, v101
    v_cvt_pk_bf16_f32 v69, v69, v69
    buffer_store_short v69, v11, s[40:43], 0 offen
    v_add_u32 v11, 10, v6
    v_mul_u32_u24 v11, 2752, v11
    v_lshlrev_b32 v12, 1, v10
    v_add_u32 v11, v11, v12
    v_cvt_pk_bf16_f32 v70, v70, v70
    v_lshlrev_b32 v70, 16, v70
    v_cvt_pk_bf16_f32 v102, v102, v102
    v_lshlrev_b32 v102, 16, v102
    v_mul_f32 v13, v70, v70
    v_mul_f32 v13, 0x3d372713, v13
    v_fma_f32 v13, v13, v70, v70
    v_mul_f32 v13, 0x40135761, v13
    v_exp_f32 v13, v13
    s_nop 0
    v_add_f32 v13, 1.0, v13
    v_rcp_f32 v13, v13
    s_nop 0
    v_fma_f32 v13, -v13, v70, v70
    v_cvt_pk_bf16_f32 v13, v13, v13
    v_lshlrev_b32 v13, 16, v13
    v_mul_f32 v70, v13, v102
    v_cvt_pk_bf16_f32 v70, v70, v70
    buffer_store_short v70, v11, s[40:43], 0 offen
    v_add_u32 v11, 11, v6
    v_mul_u32_u24 v11, 2752, v11
    v_lshlrev_b32 v12, 1, v10
    v_add_u32 v11, v11, v12
    v_cvt_pk_bf16_f32 v71, v71, v71
    v_lshlrev_b32 v71, 16, v71
    v_cvt_pk_bf16_f32 v103, v103, v103
    v_lshlrev_b32 v103, 16, v103
    v_mul_f32 v13, v71, v71
    v_mul_f32 v13, 0x3d372713, v13
    v_fma_f32 v13, v13, v71, v71
    v_mul_f32 v13, 0x40135761, v13
    v_exp_f32 v13, v13
    s_nop 0
    v_add_f32 v13, 1.0, v13
    v_rcp_f32 v13, v13
    s_nop 0
    v_fma_f32 v13, -v13, v71, v71
    v_cvt_pk_bf16_f32 v13, v13, v13
    v_lshlrev_b32 v13, 16, v13
    v_mul_f32 v71, v13, v103
    v_cvt_pk_bf16_f32 v71, v71, v71
    buffer_store_short v71, v11, s[40:43], 0 offen
    v_add_u32 v11, 16, v6
    v_mul_u32_u24 v11, 2752, v11
    v_lshlrev_b32 v12, 1, v10
    v_add_u32 v11, v11, v12
    v_cvt_pk_bf16_f32 v72, v72, v72
    v_lshlrev_b32 v72, 16, v72
    v_cvt_pk_bf16_f32 v104, v104, v104
    v_lshlrev_b32 v104, 16, v104
    v_mul_f32 v13, v72, v72
    v_mul_f32 v13, 0x3d372713, v13
    v_fma_f32 v13, v13, v72, v72
    v_mul_f32 v13, 0x40135761, v13
    v_exp_f32 v13, v13
    s_nop 0
    v_add_f32 v13, 1.0, v13
    v_rcp_f32 v13, v13
    s_nop 0
    v_fma_f32 v13, -v13, v72, v72
    v_cvt_pk_bf16_f32 v13, v13, v13
    v_lshlrev_b32 v13, 16, v13
    v_mul_f32 v72, v13, v104
    v_cvt_pk_bf16_f32 v72, v72, v72
    buffer_store_short v72, v11, s[40:43], 0 offen
    v_add_u32 v11, 17, v6
    v_mul_u32_u24 v11, 2752, v11
    v_lshlrev_b32 v12, 1, v10
    v_add_u32 v11, v11, v12
    v_cvt_pk_bf16_f32 v73, v73, v73
    v_lshlrev_b32 v73, 16, v73
    v_cvt_pk_bf16_f32 v105, v105, v105
    v_lshlrev_b32 v105, 16, v105
    v_mul_f32 v13, v73, v73
    v_mul_f32 v13, 0x3d372713, v13
    v_fma_f32 v13, v13, v73, v73
    v_mul_f32 v13, 0x40135761, v13
    v_exp_f32 v13, v13
    s_nop 0
    v_add_f32 v13, 1.0, v13
    v_rcp_f32 v13, v13
    s_nop 0
    v_fma_f32 v13, -v13, v73, v73
    v_cvt_pk_bf16_f32 v13, v13, v13
    v_lshlrev_b32 v13, 16, v13
    v_mul_f32 v73, v13, v105
    v_cvt_pk_bf16_f32 v73, v73, v73
    buffer_store_short v73, v11, s[40:43], 0 offen
    v_add_u32 v11, 18, v6
    v_mul_u32_u24 v11, 2752, v11
    v_lshlrev_b32 v12, 1, v10
    v_add_u32 v11, v11, v12
    v_cvt_pk_bf16_f32 v74, v74, v74
    v_lshlrev_b32 v74, 16, v74
    v_cvt_pk_bf16_f32 v106, v106, v106
    v_lshlrev_b32 v106, 16, v106
    v_mul_f32 v13, v74, v74
    v_mul_f32 v13, 0x3d372713, v13
    v_fma_f32 v13, v13, v74, v74
    v_mul_f32 v13, 0x40135761, v13
    v_exp_f32 v13, v13
    s_nop 0
    v_add_f32 v13, 1.0, v13
    v_rcp_f32 v13, v13
    s_nop 0
    v_fma_f32 v13, -v13, v74, v74
    v_cvt_pk_bf16_f32 v13, v13, v13
    v_lshlrev_b32 v13, 16, v13
    v_mul_f32 v74, v13, v106
    v_cvt_pk_bf16_f32 v74, v74, v74
    buffer_store_short v74, v11, s[40:43], 0 offen
    v_add_u32 v11, 19, v6
    v_mul_u32_u24 v11, 2752, v11
    v_lshlrev_b32 v12, 1, v10
    v_add_u32 v11, v11, v12
    v_cvt_pk_bf16_f32 v75, v75, v75
    v_lshlrev_b32 v75, 16, v75
    v_cvt_pk_bf16_f32 v107, v107, v107
    v_lshlrev_b32 v107, 16, v107
    v_mul_f32 v13, v75, v75
    v_mul_f32 v13, 0x3d372713, v13
    v_fma_f32 v13, v13, v75, v75
    v_mul_f32 v13, 0x40135761, v13
    v_exp_f32 v13, v13
    s_nop 0
    v_add_f32 v13, 1.0, v13
    v_rcp_f32 v13, v13
    s_nop 0
    v_fma_f32 v13, -v13, v75, v75
    v_cvt_pk_bf16_f32 v13, v13, v13
    v_lshlrev_b32 v13, 16, v13
    v_mul_f32 v75, v13, v107
    v_cvt_pk_bf16_f32 v75, v75, v75
    buffer_store_short v75, v11, s[40:43], 0 offen
    v_add_u32 v11, 24, v6
    v_mul_u32_u24 v11, 2752, v11
    v_lshlrev_b32 v12, 1, v10
    v_add_u32 v11, v11, v12
    v_cvt_pk_bf16_f32 v76, v76, v76
    v_lshlrev_b32 v76, 16, v76
    v_cvt_pk_bf16_f32 v108, v108, v108
    v_lshlrev_b32 v108, 16, v108
    v_mul_f32 v13, v76, v76
    v_mul_f32 v13, 0x3d372713, v13
    v_fma_f32 v13, v13, v76, v76
    v_mul_f32 v13, 0x40135761, v13
    v_exp_f32 v13, v13
    s_nop 0
    v_add_f32 v13, 1.0, v13
    v_rcp_f32 v13, v13
    s_nop 0
    v_fma_f32 v13, -v13, v76, v76
    v_cvt_pk_bf16_f32 v13, v13, v13
    v_lshlrev_b32 v13, 16, v13
    v_mul_f32 v76, v13, v108
    v_cvt_pk_bf16_f32 v76, v76, v76
    buffer_store_short v76, v11, s[40:43], 0 offen
    v_add_u32 v11, 25, v6
    v_mul_u32_u24 v11, 2752, v11
    v_lshlrev_b32 v12, 1, v10
    v_add_u32 v11, v11, v12
    v_cvt_pk_bf16_f32 v77, v77, v77
    v_lshlrev_b32 v77, 16, v77
    v_cvt_pk_bf16_f32 v109, v109, v109
    v_lshlrev_b32 v109, 16, v109
    v_mul_f32 v13, v77, v77
    v_mul_f32 v13, 0x3d372713, v13
    v_fma_f32 v13, v13, v77, v77
    v_mul_f32 v13, 0x40135761, v13
    v_exp_f32 v13, v13
    s_nop 0
    v_add_f32 v13, 1.0, v13
    v_rcp_f32 v13, v13
    s_nop 0
    v_fma_f32 v13, -v13, v77, v77
    v_cvt_pk_bf16_f32 v13, v13, v13
    v_lshlrev_b32 v13, 16, v13
    v_mul_f32 v77, v13, v109
    v_cvt_pk_bf16_f32 v77, v77, v77
    buffer_store_short v77, v11, s[40:43], 0 offen
    v_add_u32 v11, 26, v6
    v_mul_u32_u24 v11, 2752, v11
    v_lshlrev_b32 v12, 1, v10
    v_add_u32 v11, v11, v12
    v_cvt_pk_bf16_f32 v78, v78, v78
    v_lshlrev_b32 v78, 16, v78
    v_cvt_pk_bf16_f32 v110, v110, v110
    v_lshlrev_b32 v110, 16, v110
    v_mul_f32 v13, v78, v78
    v_mul_f32 v13, 0x3d372713, v13
    v_fma_f32 v13, v13, v78, v78
    v_mul_f32 v13, 0x40135761, v13
    v_exp_f32 v13, v13
    s_nop 0
    v_add_f32 v13, 1.0, v13
    v_rcp_f32 v13, v13
    s_nop 0
    v_fma_f32 v13, -v13, v78, v78
    v_cvt_pk_bf16_f32 v13, v13, v13
    v_lshlrev_b32 v13, 16, v13
    v_mul_f32 v78, v13, v110
    v_cvt_pk_bf16_f32 v78, v78, v78
    buffer_store_short v78, v11, s[40:43], 0 offen
    v_add_u32 v11, 27, v6
    v_mul_u32_u24 v11, 2752, v11
    v_lshlrev_b32 v12, 1, v10
    v_add_u32 v11, v11, v12
    v_cvt_pk_bf16_f32 v79, v79, v79
    v_lshlrev_b32 v79, 16, v79
    v_cvt_pk_bf16_f32 v111, v111, v111
    v_lshlrev_b32 v111, 16, v111
    v_mul_f32 v13, v79, v79
    v_mul_f32 v13, 0x3d372713, v13
    v_fma_f32 v13, v13, v79, v79
    v_mul_f32 v13, 0x40135761, v13
    v_exp_f32 v13, v13
    s_nop 0
    v_add_f32 v13, 1.0, v13
    v_rcp_f32 v13, v13
    s_nop 0
    v_fma_f32 v13, -v13, v79, v79
    v_cvt_pk_bf16_f32 v13, v13, v13
    v_lshlrev_b32 v13, 16, v13
    v_mul_f32 v79, v13, v111
    v_cvt_pk_bf16_f32 v79, v79, v79
    buffer_store_short v79, v11, s[40:43], 0 offen
    v_add_u32 v11, 32, v6
    v_mul_u32_u24 v11, 2752, v11
    v_lshlrev_b32 v12, 1, v10
    v_add_u32 v11, v11, v12
    v_cvt_pk_bf16_f32 v80, v80, v80
    v_lshlrev_b32 v80, 16, v80
    v_cvt_pk_bf16_f32 v112, v112, v112
    v_lshlrev_b32 v112, 16, v112
    v_mul_f32 v13, v80, v80
    v_mul_f32 v13, 0x3d372713, v13
    v_fma_f32 v13, v13, v80, v80
    v_mul_f32 v13, 0x40135761, v13
    v_exp_f32 v13, v13
    s_nop 0
    v_add_f32 v13, 1.0, v13
    v_rcp_f32 v13, v13
    s_nop 0
    v_fma_f32 v13, -v13, v80, v80
    v_cvt_pk_bf16_f32 v13, v13, v13
    v_lshlrev_b32 v13, 16, v13
    v_mul_f32 v80, v13, v112
    v_cvt_pk_bf16_f32 v80, v80, v80
    buffer_store_short v80, v11, s[40:43], 0 offen
    v_add_u32 v11, 33, v6
    v_mul_u32_u24 v11, 2752, v11
    v_lshlrev_b32 v12, 1, v10
    v_add_u32 v11, v11, v12
    v_cvt_pk_bf16_f32 v81, v81, v81
    v_lshlrev_b32 v81, 16, v81
    v_cvt_pk_bf16_f32 v113, v113, v113
    v_lshlrev_b32 v113, 16, v113
    v_mul_f32 v13, v81, v81
    v_mul_f32 v13, 0x3d372713, v13
    v_fma_f32 v13, v13, v81, v81
    v_mul_f32 v13, 0x40135761, v13
    v_exp_f32 v13, v13
    s_nop 0
    v_add_f32 v13, 1.0, v13
    v_rcp_f32 v13, v13
    s_nop 0
    v_fma_f32 v13, -v13, v81, v81
    v_cvt_pk_bf16_f32 v13, v13, v13
    v_lshlrev_b32 v13, 16, v13
    v_mul_f32 v81, v13, v113
    v_cvt_pk_bf16_f32 v81, v81, v81
    buffer_store_short v81, v11, s[40:43], 0 offen
    v_add_u32 v11, 34, v6
    v_mul_u32_u24 v11, 2752, v11
    v_lshlrev_b32 v12, 1, v10
    v_add_u32 v11, v11, v12
    v_cvt_pk_bf16_f32 v82, v82, v82
    v_lshlrev_b32 v82, 16, v82
    v_cvt_pk_bf16_f32 v114, v114, v114
    v_lshlrev_b32 v114, 16, v114
    v_mul_f32 v13, v82, v82
    v_mul_f32 v13, 0x3d372713, v13
    v_fma_f32 v13, v13, v82, v82
    v_mul_f32 v13, 0x40135761, v13
    v_exp_f32 v13, v13
    s_nop 0
    v_add_f32 v13, 1.0, v13
    v_rcp_f32 v13, v13
    s_nop 0
    v_fma_f32 v13, -v13, v82, v82
    v_cvt_pk_bf16_f32 v13, v13, v13
    v_lshlrev_b32 v13, 16, v13
    v_mul_f32 v82, v13, v114
    v_cvt_pk_bf16_f32 v82, v82, v82
    buffer_store_short v82, v11, s[40:43], 0 offen
    v_add_u32 v11, 35, v6
    v_mul_u32_u24 v11, 2752, v11
    v_lshlrev_b32 v12, 1, v10
    v_add_u32 v11, v11, v12
    v_cvt_pk_bf16_f32 v83, v83, v83
    v_lshlrev_b32 v83, 16, v83
    v_cvt_pk_bf16_f32 v115, v115, v115
    v_lshlrev_b32 v115, 16, v115
    v_mul_f32 v13, v83, v83
    v_mul_f32 v13, 0x3d372713, v13
    v_fma_f32 v13, v13, v83, v83
    v_mul_f32 v13, 0x40135761, v13
    v_exp_f32 v13, v13
    s_nop 0
    v_add_f32 v13, 1.0, v13
    v_rcp_f32 v13, v13
    s_nop 0
    v_fma_f32 v13, -v13, v83, v83
    v_cvt_pk_bf16_f32 v13, v13, v13
    v_lshlrev_b32 v13, 16, v13
    v_mul_f32 v83, v13, v115
    v_cvt_pk_bf16_f32 v83, v83, v83
    buffer_store_short v83, v11, s[40:43], 0 offen
    v_add_u32 v11, 40, v6
    v_mul_u32_u24 v11, 2752, v11
    v_lshlrev_b32 v12, 1, v10
    v_add_u32 v11, v11, v12
    v_cvt_pk_bf16_f32 v84, v84, v84
    v_lshlrev_b32 v84, 16, v84
    v_cvt_pk_bf16_f32 v116, v116, v116
    v_lshlrev_b32 v116, 16, v116
    v_mul_f32 v13, v84, v84
    v_mul_f32 v13, 0x3d372713, v13
    v_fma_f32 v13, v13, v84, v84
    v_mul_f32 v13, 0x40135761, v13
    v_exp_f32 v13, v13
    s_nop 0
    v_add_f32 v13, 1.0, v13
    v_rcp_f32 v13, v13
    s_nop 0
    v_fma_f32 v13, -v13, v84, v84
    v_cvt_pk_bf16_f32 v13, v13, v13
    v_lshlrev_b32 v13, 16, v13
    v_mul_f32 v84, v13, v116
    v_cvt_pk_bf16_f32 v84, v84, v84
    buffer_store_short v84, v11, s[40:43], 0 offen
    v_add_u32 v11, 41, v6
    v_mul_u32_u24 v11, 2752, v11
    v_lshlrev_b32 v12, 1, v10
    v_add_u32 v11, v11, v12
    v_cvt_pk_bf16_f32 v85, v85, v85
    v_lshlrev_b32 v85, 16, v85
    v_cvt_pk_bf16_f32 v117, v117, v117
    v_lshlrev_b32 v117, 16, v117
    v_mul_f32 v13, v85, v85
    v_mul_f32 v13, 0x3d372713, v13
    v_fma_f32 v13, v13, v85, v85
    v_mul_f32 v13, 0x40135761, v13
    v_exp_f32 v13, v13
    s_nop 0
    v_add_f32 v13, 1.0, v13
    v_rcp_f32 v13, v13
    s_nop 0
    v_fma_f32 v13, -v13, v85, v85
    v_cvt_pk_bf16_f32 v13, v13, v13
    v_lshlrev_b32 v13, 16, v13
    v_mul_f32 v85, v13, v117
    v_cvt_pk_bf16_f32 v85, v85, v85
    buffer_store_short v85, v11, s[40:43], 0 offen
    v_add_u32 v11, 42, v6
    v_mul_u32_u24 v11, 2752, v11
    v_lshlrev_b32 v12, 1, v10
    v_add_u32 v11, v11, v12
    v_cvt_pk_bf16_f32 v86, v86, v86
    v_lshlrev_b32 v86, 16, v86
    v_cvt_pk_bf16_f32 v118, v118, v118
    v_lshlrev_b32 v118, 16, v118
    v_mul_f32 v13, v86, v86
    v_mul_f32 v13, 0x3d372713, v13
    v_fma_f32 v13, v13, v86, v86
    v_mul_f32 v13, 0x40135761, v13
    v_exp_f32 v13, v13
    s_nop 0
    v_add_f32 v13, 1.0, v13
    v_rcp_f32 v13, v13
    s_nop 0
    v_fma_f32 v13, -v13, v86, v86
    v_cvt_pk_bf16_f32 v13, v13, v13
    v_lshlrev_b32 v13, 16, v13
    v_mul_f32 v86, v13, v118
    v_cvt_pk_bf16_f32 v86, v86, v86
    buffer_store_short v86, v11, s[40:43], 0 offen
    v_add_u32 v11, 43, v6
    v_mul_u32_u24 v11, 2752, v11
    v_lshlrev_b32 v12, 1, v10
    v_add_u32 v11, v11, v12
    v_cvt_pk_bf16_f32 v87, v87, v87
    v_lshlrev_b32 v87, 16, v87
    v_cvt_pk_bf16_f32 v119, v119, v119
    v_lshlrev_b32 v119, 16, v119
    v_mul_f32 v13, v87, v87
    v_mul_f32 v13, 0x3d372713, v13
    v_fma_f32 v13, v13, v87, v87
    v_mul_f32 v13, 0x40135761, v13
    v_exp_f32 v13, v13
    s_nop 0
    v_add_f32 v13, 1.0, v13
    v_rcp_f32 v13, v13
    s_nop 0
    v_fma_f32 v13, -v13, v87, v87
    v_cvt_pk_bf16_f32 v13, v13, v13
    v_lshlrev_b32 v13, 16, v13
    v_mul_f32 v87, v13, v119
    v_cvt_pk_bf16_f32 v87, v87, v87
    buffer_store_short v87, v11, s[40:43], 0 offen
    v_add_u32 v11, 48, v6
    v_mul_u32_u24 v11, 2752, v11
    v_lshlrev_b32 v12, 1, v10
    v_add_u32 v11, v11, v12
    v_cvt_pk_bf16_f32 v88, v88, v88
    v_lshlrev_b32 v88, 16, v88
    v_cvt_pk_bf16_f32 v120, v120, v120
    v_lshlrev_b32 v120, 16, v120
    v_mul_f32 v13, v88, v88
    v_mul_f32 v13, 0x3d372713, v13
    v_fma_f32 v13, v13, v88, v88
    v_mul_f32 v13, 0x40135761, v13
    v_exp_f32 v13, v13
    s_nop 0
    v_add_f32 v13, 1.0, v13
    v_rcp_f32 v13, v13
    s_nop 0
    v_fma_f32 v13, -v13, v88, v88
    v_cvt_pk_bf16_f32 v13, v13, v13
    v_lshlrev_b32 v13, 16, v13
    v_mul_f32 v88, v13, v120
    v_cvt_pk_bf16_f32 v88, v88, v88
    buffer_store_short v88, v11, s[40:43], 0 offen
    v_add_u32 v11, 49, v6
    v_mul_u32_u24 v11, 2752, v11
    v_lshlrev_b32 v12, 1, v10
    v_add_u32 v11, v11, v12
    v_cvt_pk_bf16_f32 v89, v89, v89
    v_lshlrev_b32 v89, 16, v89
    v_cvt_pk_bf16_f32 v121, v121, v121
    v_lshlrev_b32 v121, 16, v121
    v_mul_f32 v13, v89, v89
    v_mul_f32 v13, 0x3d372713, v13
    v_fma_f32 v13, v13, v89, v89
    v_mul_f32 v13, 0x40135761, v13
    v_exp_f32 v13, v13
    s_nop 0
    v_add_f32 v13, 1.0, v13
    v_rcp_f32 v13, v13
    s_nop 0
    v_fma_f32 v13, -v13, v89, v89
    v_cvt_pk_bf16_f32 v13, v13, v13
    v_lshlrev_b32 v13, 16, v13
    v_mul_f32 v89, v13, v121
    v_cvt_pk_bf16_f32 v89, v89, v89
    buffer_store_short v89, v11, s[40:43], 0 offen
    v_add_u32 v11, 50, v6
    v_mul_u32_u24 v11, 2752, v11
    v_lshlrev_b32 v12, 1, v10
    v_add_u32 v11, v11, v12
    v_cvt_pk_bf16_f32 v90, v90, v90
    v_lshlrev_b32 v90, 16, v90
    v_cvt_pk_bf16_f32 v122, v122, v122
    v_lshlrev_b32 v122, 16, v122
    v_mul_f32 v13, v90, v90
    v_mul_f32 v13, 0x3d372713, v13
    v_fma_f32 v13, v13, v90, v90
    v_mul_f32 v13, 0x40135761, v13
    v_exp_f32 v13, v13
    s_nop 0
    v_add_f32 v13, 1.0, v13
    v_rcp_f32 v13, v13
    s_nop 0
    v_fma_f32 v13, -v13, v90, v90
    v_cvt_pk_bf16_f32 v13, v13, v13
    v_lshlrev_b32 v13, 16, v13
    v_mul_f32 v90, v13, v122
    v_cvt_pk_bf16_f32 v90, v90, v90
    buffer_store_short v90, v11, s[40:43], 0 offen
    v_add_u32 v11, 51, v6
    v_mul_u32_u24 v11, 2752, v11
    v_lshlrev_b32 v12, 1, v10
    v_add_u32 v11, v11, v12
    v_cvt_pk_bf16_f32 v91, v91, v91
    v_lshlrev_b32 v91, 16, v91
    v_cvt_pk_bf16_f32 v123, v123, v123
    v_lshlrev_b32 v123, 16, v123
    v_mul_f32 v13, v91, v91
    v_mul_f32 v13, 0x3d372713, v13
    v_fma_f32 v13, v13, v91, v91
    v_mul_f32 v13, 0x40135761, v13
    v_exp_f32 v13, v13
    s_nop 0
    v_add_f32 v13, 1.0, v13
    v_rcp_f32 v13, v13
    s_nop 0
    v_fma_f32 v13, -v13, v91, v91
    v_cvt_pk_bf16_f32 v13, v13, v13
    v_lshlrev_b32 v13, 16, v13
    v_mul_f32 v91, v13, v123
    v_cvt_pk_bf16_f32 v91, v91, v91
    buffer_store_short v91, v11, s[40:43], 0 offen
    v_add_u32 v11, 56, v6
    v_mul_u32_u24 v11, 2752, v11
    v_lshlrev_b32 v12, 1, v10
    v_add_u32 v11, v11, v12
    v_cvt_pk_bf16_f32 v92, v92, v92
    v_lshlrev_b32 v92, 16, v92
    v_cvt_pk_bf16_f32 v124, v124, v124
    v_lshlrev_b32 v124, 16, v124
    v_mul_f32 v13, v92, v92
    v_mul_f32 v13, 0x3d372713, v13
    v_fma_f32 v13, v13, v92, v92
    v_mul_f32 v13, 0x40135761, v13
    v_exp_f32 v13, v13
    s_nop 0
    v_add_f32 v13, 1.0, v13
    v_rcp_f32 v13, v13
    s_nop 0
    v_fma_f32 v13, -v13, v92, v92
    v_cvt_pk_bf16_f32 v13, v13, v13
    v_lshlrev_b32 v13, 16, v13
    v_mul_f32 v92, v13, v124
    v_cvt_pk_bf16_f32 v92, v92, v92
    buffer_store_short v92, v11, s[40:43], 0 offen
    v_add_u32 v11, 57, v6
    v_mul_u32_u24 v11, 2752, v11
    v_lshlrev_b32 v12, 1, v10
    v_add_u32 v11, v11, v12
    v_cvt_pk_bf16_f32 v93, v93, v93
    v_lshlrev_b32 v93, 16, v93
    v_cvt_pk_bf16_f32 v125, v125, v125
    v_lshlrev_b32 v125, 16, v125
    v_mul_f32 v13, v93, v93
    v_mul_f32 v13, 0x3d372713, v13
    v_fma_f32 v13, v13, v93, v93
    v_mul_f32 v13, 0x40135761, v13
    v_exp_f32 v13, v13
    s_nop 0
    v_add_f32 v13, 1.0, v13
    v_rcp_f32 v13, v13
    s_nop 0
    v_fma_f32 v13, -v13, v93, v93
    v_cvt_pk_bf16_f32 v13, v13, v13
    v_lshlrev_b32 v13, 16, v13
    v_mul_f32 v93, v13, v125
    v_cvt_pk_bf16_f32 v93, v93, v93
    buffer_store_short v93, v11, s[40:43], 0 offen
    v_add_u32 v11, 58, v6
    v_mul_u32_u24 v11, 2752, v11
    v_lshlrev_b32 v12, 1, v10
    v_add_u32 v11, v11, v12
    v_cvt_pk_bf16_f32 v94, v94, v94
    v_lshlrev_b32 v94, 16, v94
    v_cvt_pk_bf16_f32 v126, v126, v126
    v_lshlrev_b32 v126, 16, v126
    v_mul_f32 v13, v94, v94
    v_mul_f32 v13, 0x3d372713, v13
    v_fma_f32 v13, v13, v94, v94
    v_mul_f32 v13, 0x40135761, v13
    v_exp_f32 v13, v13
    s_nop 0
    v_add_f32 v13, 1.0, v13
    v_rcp_f32 v13, v13
    s_nop 0
    v_fma_f32 v13, -v13, v94, v94
    v_cvt_pk_bf16_f32 v13, v13, v13
    v_lshlrev_b32 v13, 16, v13
    v_mul_f32 v94, v13, v126
    v_cvt_pk_bf16_f32 v94, v94, v94
    buffer_store_short v94, v11, s[40:43], 0 offen
    v_add_u32 v11, 59, v6
    v_mul_u32_u24 v11, 2752, v11
    v_lshlrev_b32 v12, 1, v10
    v_add_u32 v11, v11, v12
    v_cvt_pk_bf16_f32 v95, v95, v95
    v_lshlrev_b32 v95, 16, v95
    v_cvt_pk_bf16_f32 v127, v127, v127
    v_lshlrev_b32 v127, 16, v127
    v_mul_f32 v13, v95, v95
    v_mul_f32 v13, 0x3d372713, v13
    v_fma_f32 v13, v13, v95, v95
    v_mul_f32 v13, 0x40135761, v13
    v_exp_f32 v13, v13
    s_nop 0
    v_add_f32 v13, 1.0, v13
    v_rcp_f32 v13, v13
    s_nop 0
    v_fma_f32 v13, -v13, v95, v95
    v_cvt_pk_bf16_f32 v13, v13, v13
    v_lshlrev_b32 v13, 16, v13
    v_mul_f32 v95, v13, v127
    v_cvt_pk_bf16_f32 v95, v95, v95
    buffer_store_short v95, v11, s[40:43], 0 offen
K4_END:
    s_endpgm
.globl k5_kernel
.p2align 8
.type k5_kernel,@function
k5_kernel:
    s_load_dwordx16 s[16:31], s[0:1], 0
    s_load_dwordx4 s[32:35], s[0:1], 64
    s_waitcnt lgkmcnt(0)
    s_and_b32 s3, s2, 15
    s_lshr_b32 s36, s2, 4
    s_cmp_ge_u32 s36, 8
    s_cbranch_scc1 K5_END
    s_add_u32 s4, s34, 0x900000
    s_addc_u32 s5, s35, 0
    s_and_b32 s5, s5, 0xffff
    s_mov_b32 s6, 0x560000
    s_mov_b32 s7, 0x20000
    s_add_u32 s8, s34, 0x1400000
    s_addc_u32 s9, s35, 0
    s_and_b32 s9, s9, 0xffff
    s_mov_b32 s10, 0x160000
    s_mov_b32 s11, 0x20000
    s_add_u32 s12, s34, 0x500000
    s_addc_u32 s13, s35, 0
    s_and_b32 s13, s13, 0xffff
    s_mov_b32 s14, 0x200000
    s_mov_b32 s15, 0x20000
    s_mov_b32 s40, s30
    s_mov_b32 s41, s31
    s_and_b32 s41, s41, 0xffff
    s_mov_b32 s42, 0x200000
    s_mov_b32 s43, 0x20000
    s_lshl_b32 s3, s3, 7
    s_lshl_b32 s36, s36, 6
    v_and_b32 v1, 63, v0
    v_lshrrev_b32 v2, 6, v0
    v_and_b32 v3, 1, v2
    v_lshrrev_b32 v4, 1, v2
    v_lshlrev_b32 v3, 6, v3
    v_add_u32 v3, s3, v3
    v_lshlrev_b32 v4, 5, v4
    v_add_u32 v4, s36, v4
    v_and_b32 v5, 31, v1
    v_lshrrev_b32 v6, 5, v1
    v_lshlrev_b32 v6, 4, v6
    v_add_u32 v7, v3, v5
    v_mul_u32_u24 v7, 2752, v7
    v_add_u32 v7, v7, v6
    v_add_u32 v8, 88064, v7
    v_add_u32 v9, v4, v5
    v_mul_u32_u24 v9, 2816, v9
    v_add_u32 v9, v9, v6
    v_mov_b32 v64, 0
    v_mov_b32 v65, 0
    v_mov_b32 v66, 0
    v_mov_b32 v67, 0
    v_mov_b32 v68, 0
    v_mov_b32 v69, 0
    v_mov_b32 v70, 0
    v_mov_b32 v71, 0
    v_mov_b32 v72, 0
    v_mov_b32 v73, 0
    v_mov_b32 v74, 0
    v_mov_b32 v75, 0
    v_mov_b32 v76, 0
    v_mov_b32 v77, 0
    v_mov_b32 v78, 0
    v_mov_b32 v79, 0
    v_mov_b32 v80, 0
    v_mov_b32 v81, 0
    v_mov_b32 v82, 0
    v_mov_b32 v83, 0
    v_mov_b32 v84, 0
    v_mov_b32 v85, 0
    v_mov_b32 v86, 0
    v_mov_b32 v87, 0
    v_mov_b32 v88, 0
    v_mov_b32 v89, 0
    v_mov_b32 v90, 0
    v_mov_b32 v91, 0
    v_mov_b32 v92, 0
    v_mov_b32 v93, 0
    v_mov_b32 v94, 0
    v_mov_b32 v95, 0
    v_mov_b32 v96, 0
    v_mov_b32 v97, 0
    v_mov_b32 v98, 0
    v_mov_b32 v99, 0
    v_mov_b32 v100, 0
    v_mov_b32 v101, 0
    v_mov_b32 v102, 0
    v_mov_b32 v103, 0
    v_mov_b32 v104, 0
    v_mov_b32 v105, 0
    v_mov_b32 v106, 0
    v_mov_b32 v107, 0
    v_mov_b32 v108, 0
    v_mov_b32 v109, 0
    v_mov_b32 v110, 0
    v_mov_b32 v111, 0
    v_mov_b32 v112, 0
    v_mov_b32 v113, 0
    v_mov_b32 v114, 0
    v_mov_b32 v115, 0
    v_mov_b32 v116, 0
    v_mov_b32 v117, 0
    v_mov_b32 v118, 0
    v_mov_b32 v119, 0
    v_mov_b32 v120, 0
    v_mov_b32 v121, 0
    v_mov_b32 v122, 0
    v_mov_b32 v123, 0
    v_mov_b32 v124, 0
    v_mov_b32 v125, 0
    v_mov_b32 v126, 0
    v_mov_b32 v127, 0
    v_lshrrev_b32 v10, 3, v0
    v_and_b32 v11, 7, v0
    v_lshlrev_b32 v11, 4, v11
    v_mul_u32_u24 v12, 144, v10
    v_add_u32 v12, v12, v11
    v_add_u32 v13, s3, v10
    v_mul_u32_u24 v13, 2752, v13
    v_add_u32 v13, v13, v11
    v_add_u32 v14, s36, v10
    v_mul_u32_u24 v14, 2816, v14
    v_add_u32 v14, v14, v11
    v_sub_u32 v7, v3, s3
    v_add_u32 v7, v7, v5
    v_mul_u32_u24 v7, 144, v7
    v_add_u32 v7, v7, v6
    v_sub_u32 v9, v4, s36
    v_add_u32 v9, v9, v5
    v_mul_u32_u24 v9, 144, v9
    v_add_u32 v9, v9, v6
    v_add_u32 v9, 18432, v9
    v_add_u32 v15, 36864, v12
    v_add_u32 v8, 36864, v7
    v_add_u32 v10, 36864, v9
    s_mov_b32 s37, 0
    s_add_u32 s38, s37, 0
    buffer_load_dwordx4 v[16:19], v13, s[4:7], s38 offen
    s_add_u32 s38, s37, 88064
    buffer_load_dwordx4 v[20:23], v13, s[4:7], s38 offen
    s_add_u32 s38, s37, 176128
    buffer_load_dwordx4 v[24:27], v13, s[4:7], s38 offen
    s_add_u32 s38, s37, 264192
    buffer_load_dwordx4 v[28:31], v13, s[4:7], s38 offen
    s_add_u32 s38, s37, 0
    buffer_load_dwordx4 v[32:35], v14, s[8:11], s38 offen
    s_add_u32 s38, s37, 90112
    buffer_load_dwordx4 v[36:39], v14, s[8:11], s38 offen
    s_add_u32 s37, s37, 128
    s_add_u32 s38, s37, 0
    buffer_load_dwordx4 v[128:131], v13, s[4:7], s38 offen
    s_add_u32 s38, s37, 88064
    buffer_load_dwordx4 v[132:135], v13, s[4:7], s38 offen
    s_add_u32 s38, s37, 176128
    buffer_load_dwordx4 v[136:139], v13, s[4:7], s38 offen
    s_add_u32 s38, s37, 264192
    buffer_load_dwordx4 v[140:143], v13, s[4:7], s38 offen
    s_add_u32 s38, s37, 0
    buffer_load_dwordx4 v[144:147], v14, s[8:11], s38 offen
    s_add_u32 s38, s37, 90112
    buffer_load_dwordx4 v[148:151], v14, s[8:11], s38 offen
    s_waitcnt vmcnt(6)
    ds_write_b128 v12, v[16:19] offset:0
    ds_write_b128 v12, v[20:23] offset:4608
    ds_write_b128 v12, v[24:27] offset:9216
    ds_write_b128 v12, v[28:31] offset:13824
    ds_write_b128 v12, v[32:35] offset:18432
    ds_write_b128 v12, v[36:39] offset:23040
    s_waitcnt lgkmcnt(0)
    s_add_u32 s37, s37, 128
    s_add_u32 s38, s37, 0
    buffer_load_dwordx4 v[16:19], v13, s[4:7], s38 offen
    s_add_u32 s38, s37, 88064
    buffer_load_dwordx4 v[20:23], v13, s[4:7], s38 offen
    s_add_u32 s38, s37, 176128
    buffer_load_dwordx4 v[24:27], v13, s[4:7], s38 offen
    s_add_u32 s38, s37, 264192
    buffer_load_dwordx4 v[28:31], v13, s[4:7], s38 offen
    s_add_u32 s38, s37, 0
    buffer_load_dwordx4 v[32:35], v14, s[8:11], s38 offen
    s_add_u32 s38, s37, 90112
    buffer_load_dwordx4 v[36:39], v14, s[8:11], s38 offen
    s_barrier
K5_L:
    ds_read_b128 v[48:51], v7 offset:0
    ds_read_b128 v[52:55], v7 offset:4608
    ds_read_b128 v[56:59], v9 offset:0
    ds_read_b128 v[160:163], v7 offset:32
    ds_read_b128 v[164:167], v7 offset:4640
    ds_read_b128 v[168:171], v9 offset:32
    s_waitcnt lgkmcnt(3)
    v_mfma_f32_32x32x16_bf16 v[64:79], v[48:51], v[56:59], v[64:79]
    v_mfma_f32_32x32x16_bf16 v[80:95], v[52:55], v[56:59], v[80:95]
    s_nop 1
    ds_read_b128 v[48:51], v7 offset:64
    ds_read_b128 v[52:55], v7 offset:4672
    ds_read_b128 v[56:59], v9 offset:64
    s_waitcnt lgkmcnt(3)
    v_mfma_f32_32x32x16_bf16 v[64:79], v[160:163], v[168:171], v[64:79]
    v_mfma_f32_32x32x16_bf16 v[80:95], v[164:167], v[168:171], v[80:95]
    s_nop 1
    ds_read_b128 v[160:163], v7 offset:96
    ds_read_b128 v[164:167], v7 offset:4704
    ds_read_b128 v[168:171], v9 offset:96
    s_waitcnt lgkmcnt(3)
    v_mfma_f32_32x32x16_bf16 v[64:79], v[48:51], v[56:59], v[64:79]
    v_mfma_f32_32x32x16_bf16 v[80:95], v[52:55], v[56:59], v[80:95]
    s_nop 1
    s_waitcnt lgkmcnt(0)
    v_mfma_f32_32x32x16_bf16 v[64:79], v[160:163], v[168:171], v[64:79]
    v_mfma_f32_32x32x16_bf16 v[80:95], v[164:167], v[168:171], v[80:95]
    s_nop 1
    s_waitcnt vmcnt(6)
    ds_write_b128 v15, v[128:131] offset:0
    ds_write_b128 v15, v[132:135] offset:4608
    ds_write_b128 v15, v[136:139] offset:9216
    ds_write_b128 v15, v[140:143] offset:13824
    ds_write_b128 v15, v[144:147] offset:18432
    ds_write_b128 v15, v[148:151] offset:23040
    s_waitcnt lgkmcnt(0)
    s_add_u32 s37, s37, 128
    s_add_u32 s38, s37, 0
    buffer_load_dwordx4 v[128:131], v13, s[4:7], s38 offen
    s_add_u32 s38, s37, 88064
    buffer_load_dwordx4 v[132:135], v13, s[4:7], s38 offen
    s_add_u32 s38, s37, 176128
    buffer_load_dwordx4 v[136:139], v13, s[4:7], s38 offen
    s_add_u32 s38, s37, 264192
    buffer_load_dwordx4 v[140:143], v13, s[4:7], s38 offen
    s_add_u32 s38, s37, 0
    buffer_load_dwordx4 v[144:147], v14, s[8:11], s38 offen
    s_add_u32 s38, s37, 90112
    buffer_load_dwordx4 v[148:151], v14, s[8:11], s38 offen
    s_barrier
    s_cmp_gt_u32 s37, 3071
    s_cbranch_scc1 K5_D
    ds_read_b128 v[48:51], v8 offset:0
    ds_read_b128 v[52:55], v8 offset:4608
    ds_read_b128 v[56:59], v10 offset:0
    ds_read_b128 v[160:163], v8 offset:32
    ds_read_b128 v[164:167], v8 offset:4640
    ds_read_b128 v[168:171], v10 offset:32
    s_waitcnt lgkmcnt(3)
    v_mfma_f32_32x32x16_bf16 v[64:79], v[48:51], v[56:59], v[64:79]
    v_mfma_f32_32x32x16_bf16 v[80:95], v[52:55], v[56:59], v[80:95]
    s_nop 1
    ds_read_b128 v[48:51], v8 offset:64
    ds_read_b128 v[52:55], v8 offset:4672
    ds_read_b128 v[56:59], v10 offset:64
    s_waitcnt lgkmcnt(3)
    v_mfma_f32_32x32x16_bf16 v[64:79], v[160:163], v[168:171], v[64:79]
    v_mfma_f32_32x32x16_bf16 v[80:95], v[164:167], v[168:171], v[80:95]
    s_nop 1
    ds_read_b128 v[160:163], v8 offset:96
    ds_read_b128 v[164:167], v8 offset:4704
    ds_read_b128 v[168:171], v10 offset:96
    s_waitcnt lgkmcnt(3)
    v_mfma_f32_32x32x16_bf16 v[64:79], v[48:51], v[56:59], v[64:79]
    v_mfma_f32_32x32x16_bf16 v[80:95], v[52:55], v[56:59], v[80:95]
    s_nop 1
    s_waitcnt lgkmcnt(0)
    v_mfma_f32_32x32x16_bf16 v[64:79], v[160:163], v[168:171], v[64:79]
    v_mfma_f32_32x32x16_bf16 v[80:95], v[164:167], v[168:171], v[80:95]
    s_nop 1
    s_waitcnt vmcnt(6)
    ds_write_b128 v12, v[16:19] offset:0
    ds_write_b128 v12, v[20:23] offset:4608
    ds_write_b128 v12, v[24:27] offset:9216
    ds_write_b128 v12, v[28:31] offset:13824
    ds_write_b128 v12, v[32:35] offset:18432
    ds_write_b128 v12, v[36:39] offset:23040
    s_waitcnt lgkmcnt(0)
    s_add_u32 s37, s37, 128
    s_add_u32 s38, s37, 0
    buffer_load_dwordx4 v[16:19], v13, s[4:7], s38 offen
    s_add_u32 s38, s37, 88064
    buffer_load_dwordx4 v[20:23], v13, s[4:7], s38 offen
    s_add_u32 s38, s37, 176128
    buffer_load_dwordx4 v[24:27], v13, s[4:7], s38 offen
    s_add_u32 s38, s37, 264192
    buffer_load_dwordx4 v[28:31], v13, s[4:7], s38 offen
    s_add_u32 s38, s37, 0
    buffer_load_dwordx4 v[32:35], v14, s[8:11], s38 offen
    s_add_u32 s38, s37, 90112
    buffer_load_dwordx4 v[36:39], v14, s[8:11], s38 offen
    s_barrier
    s_cmp_gt_u32 s37, 3071
    s_cbranch_scc1 K5_D
    s_branch K5_L
K5_D:
    s_waitcnt vmcnt(0)
    s_nop 15
    s_nop 15
    v_add_u32 v10, v4, v5
    v_lshrrev_b32 v6, 5, v1
    v_lshlrev_b32 v6, 2, v6
    v_add_u32 v6, v6, v3
    v_add_u32 v11, 0, v6
    v_lshlrev_b32 v11, 10, v11
    v_lshlrev_b32 v12, 1, v10
    v_add_u32 v16, v11, v12
    buffer_load_ushort v96, v16, s[12:15], 0 offen
    v_add_u32 v11, 1, v6
    v_lshlrev_b32 v11, 10, v11
    v_lshlrev_b32 v12, 1, v10
    v_add_u32 v17, v11, v12
    buffer_load_ushort v97, v17, s[12:15], 0 offen
    v_add_u32 v11, 2, v6
    v_lshlrev_b32 v11, 10, v11
    v_lshlrev_b32 v12, 1, v10
    v_add_u32 v18, v11, v12
    buffer_load_ushort v98, v18, s[12:15], 0 offen
    v_add_u32 v11, 3, v6
    v_lshlrev_b32 v11, 10, v11
    v_lshlrev_b32 v12, 1, v10
    v_add_u32 v19, v11, v12
    buffer_load_ushort v99, v19, s[12:15], 0 offen
    v_add_u32 v11, 8, v6
    v_lshlrev_b32 v11, 10, v11
    v_lshlrev_b32 v12, 1, v10
    v_add_u32 v20, v11, v12
    buffer_load_ushort v100, v20, s[12:15], 0 offen
    v_add_u32 v11, 9, v6
    v_lshlrev_b32 v11, 10, v11
    v_lshlrev_b32 v12, 1, v10
    v_add_u32 v21, v11, v12
    buffer_load_ushort v101, v21, s[12:15], 0 offen
    v_add_u32 v11, 10, v6
    v_lshlrev_b32 v11, 10, v11
    v_lshlrev_b32 v12, 1, v10
    v_add_u32 v22, v11, v12
    buffer_load_ushort v102, v22, s[12:15], 0 offen
    v_add_u32 v11, 11, v6
    v_lshlrev_b32 v11, 10, v11
    v_lshlrev_b32 v12, 1, v10
    v_add_u32 v23, v11, v12
    buffer_load_ushort v103, v23, s[12:15], 0 offen
    v_add_u32 v11, 16, v6
    v_lshlrev_b32 v11, 10, v11
    v_lshlrev_b32 v12, 1, v10
    v_add_u32 v24, v11, v12
    buffer_load_ushort v104, v24, s[12:15], 0 offen
    v_add_u32 v11, 17, v6
    v_lshlrev_b32 v11, 10, v11
    v_lshlrev_b32 v12, 1, v10
    v_add_u32 v25, v11, v12
    buffer_load_ushort v105, v25, s[12:15], 0 offen
    v_add_u32 v11, 18, v6
    v_lshlrev_b32 v11, 10, v11
    v_lshlrev_b32 v12, 1, v10
    v_add_u32 v26, v11, v12
    buffer_load_ushort v106, v26, s[12:15], 0 offen
    v_add_u32 v11, 19, v6
    v_lshlrev_b32 v11, 10, v11
    v_lshlrev_b32 v12, 1, v10
    v_add_u32 v27, v11, v12
    buffer_load_ushort v107, v27, s[12:15], 0 offen
    v_add_u32 v11, 24, v6
    v_lshlrev_b32 v11, 10, v11
    v_lshlrev_b32 v12, 1, v10
    v_add_u32 v28, v11, v12
    buffer_load_ushort v108, v28, s[12:15], 0 offen
    v_add_u32 v11, 25, v6
    v_lshlrev_b32 v11, 10, v11
    v_lshlrev_b32 v12, 1, v10
    v_add_u32 v29, v11, v12
    buffer_load_ushort v109, v29, s[12:15], 0 offen
    v_add_u32 v11, 26, v6
    v_lshlrev_b32 v11, 10, v11
    v_lshlrev_b32 v12, 1, v10
    v_add_u32 v30, v11, v12
    buffer_load_ushort v110, v30, s[12:15], 0 offen
    v_add_u32 v11, 27, v6
    v_lshlrev_b32 v11, 10, v11
    v_lshlrev_b32 v12, 1, v10
    v_add_u32 v31, v11, v12
    buffer_load_ushort v111, v31, s[12:15], 0 offen
    v_add_u32 v11, 32, v6
    v_lshlrev_b32 v11, 10, v11
    v_lshlrev_b32 v12, 1, v10
    v_add_u32 v32, v11, v12
    buffer_load_ushort v112, v32, s[12:15], 0 offen
    v_add_u32 v11, 33, v6
    v_lshlrev_b32 v11, 10, v11
    v_lshlrev_b32 v12, 1, v10
    v_add_u32 v33, v11, v12
    buffer_load_ushort v113, v33, s[12:15], 0 offen
    v_add_u32 v11, 34, v6
    v_lshlrev_b32 v11, 10, v11
    v_lshlrev_b32 v12, 1, v10
    v_add_u32 v34, v11, v12
    buffer_load_ushort v114, v34, s[12:15], 0 offen
    v_add_u32 v11, 35, v6
    v_lshlrev_b32 v11, 10, v11
    v_lshlrev_b32 v12, 1, v10
    v_add_u32 v35, v11, v12
    buffer_load_ushort v115, v35, s[12:15], 0 offen
    v_add_u32 v11, 40, v6
    v_lshlrev_b32 v11, 10, v11
    v_lshlrev_b32 v12, 1, v10
    v_add_u32 v36, v11, v12
    buffer_load_ushort v116, v36, s[12:15], 0 offen
    v_add_u32 v11, 41, v6
    v_lshlrev_b32 v11, 10, v11
    v_lshlrev_b32 v12, 1, v10
    v_add_u32 v37, v11, v12
    buffer_load_ushort v117, v37, s[12:15], 0 offen
    v_add_u32 v11, 42, v6
    v_lshlrev_b32 v11, 10, v11
    v_lshlrev_b32 v12, 1, v10
    v_add_u32 v38, v11, v12
    buffer_load_ushort v118, v38, s[12:15], 0 offen
    v_add_u32 v11, 43, v6
    v_lshlrev_b32 v11, 10, v11
    v_lshlrev_b32 v12, 1, v10
    v_add_u32 v39, v11, v12
    buffer_load_ushort v119, v39, s[12:15], 0 offen
    v_add_u32 v11, 48, v6
    v_lshlrev_b32 v11, 10, v11
    v_lshlrev_b32 v12, 1, v10
    v_add_u32 v40, v11, v12
    buffer_load_ushort v120, v40, s[12:15], 0 offen
    v_add_u32 v11, 49, v6
    v_lshlrev_b32 v11, 10, v11
    v_lshlrev_b32 v12, 1, v10
    v_add_u32 v41, v11, v12
    buffer_load_ushort v121, v41, s[12:15], 0 offen
    v_add_u32 v11, 50, v6
    v_lshlrev_b32 v11, 10, v11
    v_lshlrev_b32 v12, 1, v10
    v_add_u32 v42, v11, v12
    buffer_load_ushort v122, v42, s[12:15], 0 offen
    v_add_u32 v11, 51, v6
    v_lshlrev_b32 v11, 10, v11
    v_lshlrev_b32 v12, 1, v10
    v_add_u32 v43, v11, v12
    buffer_load_ushort v123, v43, s[12:15], 0 offen
    v_add_u32 v11, 56, v6
    v_lshlrev_b32 v11, 10, v11
    v_lshlrev_b32 v12, 1, v10
    v_add_u32 v44, v11, v12
    buffer_load_ushort v124, v44, s[12:15], 0 offen
    v_add_u32 v11, 57, v6
    v_lshlrev_b32 v11, 10, v11
    v_lshlrev_b32 v12, 1, v10
    v_add_u32 v45, v11, v12
    buffer_load_ushort v125, v45, s[12:15], 0 offen
    v_add_u32 v11, 58, v6
    v_lshlrev_b32 v11, 10, v11
    v_lshlrev_b32 v12, 1, v10
    v_add_u32 v46, v11, v12
    buffer_load_ushort v126, v46, s[12:15], 0 offen
    v_add_u32 v11, 59, v6
    v_lshlrev_b32 v11, 10, v11
    v_lshlrev_b32 v12, 1, v10
    v_add_u32 v47, v11, v12
    buffer_load_ushort v127, v47, s[12:15], 0 offen
    s_waitcnt vmcnt(0)
    v_cvt_pk_bf16_f32 v64, v64, v64
    v_lshlrev_b32 v64, 16, v64
    v_lshlrev_b32 v96, 16, v96
    v_add_f32 v64, v96, v64
    v_cvt_pk_bf16_f32 v64, v64, v64
    buffer_store_short v64, v16, s[40:43], 0 offen
    v_cvt_pk_bf16_f32 v65, v65, v65
    v_lshlrev_b32 v65, 16, v65
    v_lshlrev_b32 v97, 16, v97
    v_add_f32 v65, v97, v65
    v_cvt_pk_bf16_f32 v65, v65, v65
    buffer_store_short v65, v17, s[40:43], 0 offen
    v_cvt_pk_bf16_f32 v66, v66, v66
    v_lshlrev_b32 v66, 16, v66
    v_lshlrev_b32 v98, 16, v98
    v_add_f32 v66, v98, v66
    v_cvt_pk_bf16_f32 v66, v66, v66
    buffer_store_short v66, v18, s[40:43], 0 offen
    v_cvt_pk_bf16_f32 v67, v67, v67
    v_lshlrev_b32 v67, 16, v67
    v_lshlrev_b32 v99, 16, v99
    v_add_f32 v67, v99, v67
    v_cvt_pk_bf16_f32 v67, v67, v67
    buffer_store_short v67, v19, s[40:43], 0 offen
    v_cvt_pk_bf16_f32 v68, v68, v68
    v_lshlrev_b32 v68, 16, v68
    v_lshlrev_b32 v100, 16, v100
    v_add_f32 v68, v100, v68
    v_cvt_pk_bf16_f32 v68, v68, v68
    buffer_store_short v68, v20, s[40:43], 0 offen
    v_cvt_pk_bf16_f32 v69, v69, v69
    v_lshlrev_b32 v69, 16, v69
    v_lshlrev_b32 v101, 16, v101
    v_add_f32 v69, v101, v69
    v_cvt_pk_bf16_f32 v69, v69, v69
    buffer_store_short v69, v21, s[40:43], 0 offen
    v_cvt_pk_bf16_f32 v70, v70, v70
    v_lshlrev_b32 v70, 16, v70
    v_lshlrev_b32 v102, 16, v102
    v_add_f32 v70, v102, v70
    v_cvt_pk_bf16_f32 v70, v70, v70
    buffer_store_short v70, v22, s[40:43], 0 offen
    v_cvt_pk_bf16_f32 v71, v71, v71
    v_lshlrev_b32 v71, 16, v71
    v_lshlrev_b32 v103, 16, v103
    v_add_f32 v71, v103, v71
    v_cvt_pk_bf16_f32 v71, v71, v71
    buffer_store_short v71, v23, s[40:43], 0 offen
    v_cvt_pk_bf16_f32 v72, v72, v72
    v_lshlrev_b32 v72, 16, v72
    v_lshlrev_b32 v104, 16, v104
    v_add_f32 v72, v104, v72
    v_cvt_pk_bf16_f32 v72, v72, v72
    buffer_store_short v72, v24, s[40:43], 0 offen
    v_cvt_pk_bf16_f32 v73, v73, v73
    v_lshlrev_b32 v73, 16, v73
    v_lshlrev_b32 v105, 16, v105
    v_add_f32 v73, v105, v73
    v_cvt_pk_bf16_f32 v73, v73, v73
    buffer_store_short v73, v25, s[40:43], 0 offen
    v_cvt_pk_bf16_f32 v74, v74, v74
    v_lshlrev_b32 v74, 16, v74
    v_lshlrev_b32 v106, 16, v106
    v_add_f32 v74, v106, v74
    v_cvt_pk_bf16_f32 v74, v74, v74
    buffer_store_short v74, v26, s[40:43], 0 offen
    v_cvt_pk_bf16_f32 v75, v75, v75
    v_lshlrev_b32 v75, 16, v75
    v_lshlrev_b32 v107, 16, v107
    v_add_f32 v75, v107, v75
    v_cvt_pk_bf16_f32 v75, v75, v75
    buffer_store_short v75, v27, s[40:43], 0 offen
    v_cvt_pk_bf16_f32 v76, v76, v76
    v_lshlrev_b32 v76, 16, v76
    v_lshlrev_b32 v108, 16, v108
    v_add_f32 v76, v108, v76
    v_cvt_pk_bf16_f32 v76, v76, v76
    buffer_store_short v76, v28, s[40:43], 0 offen
    v_cvt_pk_bf16_f32 v77, v77, v77
    v_lshlrev_b32 v77, 16, v77
    v_lshlrev_b32 v109, 16, v109
    v_add_f32 v77, v109, v77
    v_cvt_pk_bf16_f32 v77, v77, v77
    buffer_store_short v77, v29, s[40:43], 0 offen
    v_cvt_pk_bf16_f32 v78, v78, v78
    v_lshlrev_b32 v78, 16, v78
    v_lshlrev_b32 v110, 16, v110
    v_add_f32 v78, v110, v78
    v_cvt_pk_bf16_f32 v78, v78, v78
    buffer_store_short v78, v30, s[40:43], 0 offen
    v_cvt_pk_bf16_f32 v79, v79, v79
    v_lshlrev_b32 v79, 16, v79
    v_lshlrev_b32 v111, 16, v111
    v_add_f32 v79, v111, v79
    v_cvt_pk_bf16_f32 v79, v79, v79
    buffer_store_short v79, v31, s[40:43], 0 offen
    v_cvt_pk_bf16_f32 v80, v80, v80
    v_lshlrev_b32 v80, 16, v80
    v_lshlrev_b32 v112, 16, v112
    v_add_f32 v80, v112, v80
    v_cvt_pk_bf16_f32 v80, v80, v80
    buffer_store_short v80, v32, s[40:43], 0 offen
    v_cvt_pk_bf16_f32 v81, v81, v81
    v_lshlrev_b32 v81, 16, v81
    v_lshlrev_b32 v113, 16, v113
    v_add_f32 v81, v113, v81
    v_cvt_pk_bf16_f32 v81, v81, v81
    buffer_store_short v81, v33, s[40:43], 0 offen
    v_cvt_pk_bf16_f32 v82, v82, v82
    v_lshlrev_b32 v82, 16, v82
    v_lshlrev_b32 v114, 16, v114
    v_add_f32 v82, v114, v82
    v_cvt_pk_bf16_f32 v82, v82, v82
    buffer_store_short v82, v34, s[40:43], 0 offen
    v_cvt_pk_bf16_f32 v83, v83, v83
    v_lshlrev_b32 v83, 16, v83
    v_lshlrev_b32 v115, 16, v115
    v_add_f32 v83, v115, v83
    v_cvt_pk_bf16_f32 v83, v83, v83
    buffer_store_short v83, v35, s[40:43], 0 offen
    v_cvt_pk_bf16_f32 v84, v84, v84
    v_lshlrev_b32 v84, 16, v84
    v_lshlrev_b32 v116, 16, v116
    v_add_f32 v84, v116, v84
    v_cvt_pk_bf16_f32 v84, v84, v84
    buffer_store_short v84, v36, s[40:43], 0 offen
    v_cvt_pk_bf16_f32 v85, v85, v85
    v_lshlrev_b32 v85, 16, v85
    v_lshlrev_b32 v117, 16, v117
    v_add_f32 v85, v117, v85
    v_cvt_pk_bf16_f32 v85, v85, v85
    buffer_store_short v85, v37, s[40:43], 0 offen
    v_cvt_pk_bf16_f32 v86, v86, v86
    v_lshlrev_b32 v86, 16, v86
    v_lshlrev_b32 v118, 16, v118
    v_add_f32 v86, v118, v86
    v_cvt_pk_bf16_f32 v86, v86, v86
    buffer_store_short v86, v38, s[40:43], 0 offen
    v_cvt_pk_bf16_f32 v87, v87, v87
    v_lshlrev_b32 v87, 16, v87
    v_lshlrev_b32 v119, 16, v119
    v_add_f32 v87, v119, v87
    v_cvt_pk_bf16_f32 v87, v87, v87
    buffer_store_short v87, v39, s[40:43], 0 offen
    v_cvt_pk_bf16_f32 v88, v88, v88
    v_lshlrev_b32 v88, 16, v88
    v_lshlrev_b32 v120, 16, v120
    v_add_f32 v88, v120, v88
    v_cvt_pk_bf16_f32 v88, v88, v88
    buffer_store_short v88, v40, s[40:43], 0 offen
    v_cvt_pk_bf16_f32 v89, v89, v89
    v_lshlrev_b32 v89, 16, v89
    v_lshlrev_b32 v121, 16, v121
    v_add_f32 v89, v121, v89
    v_cvt_pk_bf16_f32 v89, v89, v89
    buffer_store_short v89, v41, s[40:43], 0 offen
    v_cvt_pk_bf16_f32 v90, v90, v90
    v_lshlrev_b32 v90, 16, v90
    v_lshlrev_b32 v122, 16, v122
    v_add_f32 v90, v122, v90
    v_cvt_pk_bf16_f32 v90, v90, v90
    buffer_store_short v90, v42, s[40:43], 0 offen
    v_cvt_pk_bf16_f32 v91, v91, v91
    v_lshlrev_b32 v91, 16, v91
    v_lshlrev_b32 v123, 16, v123
    v_add_f32 v91, v123, v91
    v_cvt_pk_bf16_f32 v91, v91, v91
    buffer_store_short v91, v43, s[40:43], 0 offen
    v_cvt_pk_bf16_f32 v92, v92, v92
    v_lshlrev_b32 v92, 16, v92
    v_lshlrev_b32 v124, 16, v124
    v_add_f32 v92, v124, v92
    v_cvt_pk_bf16_f32 v92, v92, v92
    buffer_store_short v92, v44, s[40:43], 0 offen
    v_cvt_pk_bf16_f32 v93, v93, v93
    v_lshlrev_b32 v93, 16, v93
    v_lshlrev_b32 v125, 16, v125
    v_add_f32 v93, v125, v93
    v_cvt_pk_bf16_f32 v93, v93, v93
    buffer_store_short v93, v45, s[40:43], 0 offen
    v_cvt_pk_bf16_f32 v94, v94, v94
    v_lshlrev_b32 v94, 16, v94
    v_lshlrev_b32 v126, 16, v126
    v_add_f32 v94, v126, v94
    v_cvt_pk_bf16_f32 v94, v94, v94
    buffer_store_short v94, v46, s[40:43], 0 offen
    v_cvt_pk_bf16_f32 v95, v95, v95
    v_lshlrev_b32 v95, 16, v95
    v_lshlrev_b32 v127, 16, v127
    v_add_f32 v95, v127, v95
    v_cvt_pk_bf16_f32 v95, v95, v95
    buffer_store_short v95, v47, s[40:43], 0 offen
K5_END:
    s_endpgm
.section .rodata,"a"
.p2align 6
.amdhsa_kernel k1_kernel
  .amdhsa_next_free_vgpr 80
  .amdhsa_next_free_sgpr 48
  .amdhsa_accum_offset 80
  .amdhsa_group_segment_fixed_size 0
  .amdhsa_kernarg_size 80
  .amdhsa_user_sgpr_count 2
  .amdhsa_user_sgpr_kernarg_segment_ptr 1
  .amdhsa_system_sgpr_workgroup_id_x 1
.end_amdhsa_kernel
.p2align 6
.amdhsa_kernel k2_kernel
  .amdhsa_next_free_vgpr 96
  .amdhsa_next_free_sgpr 48
  .amdhsa_accum_offset 96
  .amdhsa_group_segment_fixed_size 0
  .amdhsa_kernarg_size 80
  .amdhsa_user_sgpr_count 2
  .amdhsa_user_sgpr_kernarg_segment_ptr 1
  .amdhsa_system_sgpr_workgroup_id_x 1
.end_amdhsa_kernel
.p2align 6
.amdhsa_kernel k3_kernel
  .amdhsa_next_free_vgpr 80
  .amdhsa_next_free_sgpr 48
  .amdhsa_accum_offset 80
  .amdhsa_group_segment_fixed_size 0
  .amdhsa_kernarg_size 80
  .amdhsa_user_sgpr_count 2
  .amdhsa_user_sgpr_kernarg_segment_ptr 1
  .amdhsa_system_sgpr_workgroup_id_x 1
.end_amdhsa_kernel
.p2align 6
.amdhsa_kernel k4_kernel
  .amdhsa_next_free_vgpr 176
  .amdhsa_next_free_sgpr 48
  .amdhsa_accum_offset 176
  .amdhsa_group_segment_fixed_size 0
  .amdhsa_kernarg_size 80
  .amdhsa_user_sgpr_count 2
  .amdhsa_user_sgpr_kernarg_segment_ptr 1
  .amdhsa_system_sgpr_workgroup_id_x 1
.end_amdhsa_kernel
.p2align 6
.amdhsa_kernel k5_kernel
  .amdhsa_next_free_vgpr 176
  .amdhsa_next_free_sgpr 48
  .amdhsa_accum_offset 176
  .amdhsa_group_segment_fixed_size 0
  .amdhsa_kernarg_size 80
  .amdhsa_user_sgpr_count 2
  .amdhsa_user_sgpr_kernarg_segment_ptr 1
  .amdhsa_system_sgpr_workgroup_id_x 1
.end_amdhsa_kernel
```
